```python
import torch

def _softmax(x, axis=-1):
    return torch.softmax(x, dim=axis)
def _gelu(x):
    return torch.nn.functional.gelu(x, approximate="tanh")
def _silu(x):
    return torch.nn.functional.silu(x)
def _sigmoid(x):
    return torch.sigmoid(x)
def _layernorm(x, axis=-1, eps=1e-5):
    m = x.mean(dim=axis, keepdim=True)
    v = x.var(dim=axis, keepdim=True, unbiased=False)
    return (x - m) / torch.sqrt(v + eps)
def _scatter_add(tgt, idx, src, axis=0):
    return tgt.clone().index_add_(axis, idx, src)
def _segment_sum(src, seg, n):
    out = torch.zeros((n,) + src.shape[1:], dtype=src.dtype)
    return out.index_add_(0, seg, src)
def _pad(x, pw):
    flat = tuple(v for pair in reversed(pw) for v in pair)
    return torch.nn.functional.pad(x, flat)

kernel_name = 'gated_mix__ssm_conv_h3__ssm_conv_s4__prompt'

def setup_inputs():

    _w = (lambda a: (lambda t: t.to(torch.bfloat16) if t.is_floating_point() else t)(torch.as_tensor(a)))
    def _A_setup():
        B, S, D = 1, 2048, 512
        ks = 4
        return {
            "q": _w((lambda *s: torch.randn(*s, dtype=torch.bfloat16) * 0.05)(B, S, D)),
            "k": _w((lambda *s: torch.randn(*s, dtype=torch.bfloat16) * 0.4)(B, S, D)),
            "v": _w((lambda *s: torch.randn(*s, dtype=torch.bfloat16) * 0.2)(B, S, D)),
            "shift_k": _w((lambda *s: torch.randn(*s, dtype=torch.bfloat16) * 0.4)(D, ks) * 0.5),
            "ssm_k": _w((lambda *s: torch.randn(*s, dtype=torch.bfloat16) * 0.4)(D, S) * (1.0 / S ** 0.5)),
            "ssm_D": _w((lambda *s: torch.randn(*s, dtype=torch.bfloat16) * 0.2)(D)),
        }
    _A_in = _A_setup()

    def _B_setup():
        B, L, D, N = 1, 2048, 512, 128
        A_re = -(lambda _x: torch.exp(torch.as_tensor(_x)))((lambda *s: torch.randn(*s, dtype=torch.bfloat16) * 3.2)(D, N))
        A_im = torch.pi * (lambda *s: torch.randn(*s, dtype=torch.bfloat16) * 0.05)(D, N)
        B_re = (lambda *s: torch.randn(*s, dtype=torch.bfloat16) * 0.1)(D, N)
        B_im = (lambda *s: torch.randn(*s, dtype=torch.bfloat16) * 0.1)(D, N)
        C_re = (lambda *s: torch.randn(*s, dtype=torch.bfloat16) * 0.1)(D, N)
        C_im = (lambda *s: torch.randn(*s, dtype=torch.bfloat16) * 0.1)(D, N)
        log_dt = (lambda *s: torch.randn(*s, dtype=torch.bfloat16) * 0.05)(D) * 0.5 - 4.0
        Dskip = (lambda *s: torch.randn(*s, dtype=torch.bfloat16) * 0.05)(D)
        return {
            "u": _w((lambda *s: torch.randn(*s, dtype=torch.bfloat16) * 0.05)(B, L, D)),
            "A_re": _w(A_re),
            "A_im": _w(A_im),
            "B_re": _w(B_re),
            "B_im": _w(B_im),
            "C_re": _w(C_re),
            "C_im": _w(C_im),
            "log_dt": _w(log_dt),
            "Dskip": _w(Dskip),
        }
    _B_in = _B_setup()

    return {
        "A_q": _A_in["q"],
        "A_k": _A_in["k"],
        "A_v": _A_in["v"],
        "A_shift_k": _A_in["shift_k"],
        "A_ssm_k": _A_in["ssm_k"],
        "A_ssm_D": _A_in["ssm_D"],
        "B_u": _B_in["u"],
        "B_A_re": _B_in["A_re"],
        "B_A_im": _B_in["A_im"],
        "B_B_re": _B_in["B_re"],
        "B_B_im": _B_in["B_im"],
        "B_C_re": _B_in["C_re"],
        "B_C_im": _B_in["C_im"],
        "B_log_dt": _B_in["log_dt"],
        "B_Dskip": _B_in["Dskip"],
        "gate_w": _w((lambda *s: torch.randn(*s, dtype=torch.bfloat16) * 0.05)(512) * 16.0),
    }

def reference(A_q, A_k, A_v, A_shift_k, A_ssm_k, A_ssm_D, B_u, B_A_re, B_A_im, B_B_re, B_B_im, B_C_re, B_C_im, B_log_dt, B_Dskip, gate_w):
    def _A_ref(q, k, v, shift_k, ssm_k, ssm_D):
        B, S, D = q.shape
        ks = shift_k.shape[-1]
        k_pad = _pad(k, ((0, 0), (ks - 1, 0), (0, 0)))
        k_shift = torch.zeros_like(k)
        for t in range(ks):
            k_shift = k_shift + k_pad[:, t:t + S, :] * shift_k[:, ks - 1 - t][None, None, :]
        kv = k_shift * v
        L = 2 * S
        kv_pad = _pad(kv, ((0, 0), (0, S), (0, 0)))
        kf_pad = _pad(ssm_k, ((0, 0), (0, S)))
        kv_f = (lambda x, axes=(-2,-1): torch.fft.rfft2(x.float(), dim=axes))(kv_pad[:, None, :, :], axes=(1, 2))
        kf_f = (lambda x, axes=(-2,-1): torch.fft.rfft2(x.float(), dim=axes))(kf_pad[:, None, :], axes=(1, 2))
        kf_f = (lambda x, *d: x.permute(*d))(kf_f, 1, 2, 0)
        y_f = kv_f * kf_f[None, :, :, :]
        y = (lambda x, s, axes=(-2,-1): torch.fft.irfft2(x, s=s, dim=axes).to(torch.bfloat16))(y_f, (1, L), axes=(1, 2))[:, 0, :S, :]
        y = y + kv * ssm_D[None, None, :]
        return q * y

    def _B_ref(u, A_re, A_im, B_re, B_im, C_re, C_im, log_dt, Dskip):
        Bsz, L, D = u.shape
        dt = torch.exp(log_dt)[:, None]
        A = A_re + 1j * A_im
        Bc = B_re + 1j * B_im
        Cc = C_re + 1j * C_im
        logdA = dt * A
        dB = dt * Bc
        l = (lambda x, dt: x.to(dt))(torch.arange(L), A_re.dtype)
        P = torch.exp(logdA[:, :, None] * l[None, None, :])
        K = torch.einsum("dn,dnl,dn->dl", Cc, P, dB).real
        L2 = 2 * L
        Kp = _pad(K, ((0, 0), (0, L)))
        up = (lambda x, *d: x.permute(*d))(u, 0, 2, 1)
        up = _pad(up, ((0, 0), (0, 0), (0, L)))
        Kf = (lambda x, axes=(-2,-1): torch.fft.rfft2(x.float(), dim=axes))(Kp[:, None, :], axes=(-2, -1))
        Uf = (lambda x, axes=(-2,-1): torch.fft.rfft2(x.float(), dim=axes))(up[:, :, None, :], axes=(-2, -1))
        Yf = Uf * Kf[None, :, :, :]
        y = (lambda x, s, axes=(-2,-1): torch.fft.irfft2(x, s=s, dim=axes).to(torch.bfloat16))(Yf, (1, L2), axes=(-2, -1))[:, :, 0, :L]
        y = (lambda x, *d: x.permute(*d))(y, 0, 2, 1) + u * Dskip[None, None, :]
        return y

    x = A_q
    g = _sigmoid((x * gate_w).sum(-1, keepdims=True))
    a = _A_ref(x, A_k, A_v, A_shift_k, A_ssm_k, A_ssm_D)
    b = _B_ref(x, B_A_re, B_A_im, B_B_re, B_B_im, B_C_re, B_C_im, B_log_dt, B_Dskip)
    return g * a + (1 - g) * b
```

```asm
; @launch grid=(256,1,1) block=(512,1,1) lds=139328
.amdgcn_target "amdgcn-amd-amdhsa--gfx950"
.text
.globl gated_mix__ssm_conv_h3__ssm_conv_s4__prompt_kernel
.p2align 8
.type gated_mix__ssm_conv_h3__ssm_conv_s4__prompt_kernel,@function
gated_mix__ssm_conv_h3__ssm_conv_s4__prompt_kernel:
    s_cmp_ge_u32 s2, 256
    s_cbranch_scc1 L_end
    s_load_dwordx8 s[4:11], s[0:1], 0
    s_load_dwordx4 s[40:43], s[0:1], 32
    s_load_dwordx16 s[16:31], s[0:1], 56
    s_load_dwordx2 s[32:33], s[0:1], 120
    s_load_dwordx4 s[36:39], s[0:1], 128
    s_load_dwordx2 s[34:35], s[0:1], 144
    v_lshrrev_b32 v1, 6, v0
    v_and_b32 v2, 63, v0
    v_readfirstlane_b32 s14, v1
    s_and_b32 s12, s2, 7
    s_lshr_b32 s13, s2, 3
    s_lshl_b32 s15, s12, 5
    s_add_u32 s15, s15, s13
    s_lshl_b32 s66, s15, 2
    v_lshlrev_b32 v53, 4, v2
    s_cmp_lt_u32 s14, 4
    s_cbranch_scc1 L_Tfront
    s_lshl_b32 s60, s12, 7
    s_lshl_b32 s61, s13, 16
    s_add_u32 s62, s60, s61
    v_bfe_u32 v3, v0, 4, 4
    v_and_b32 v54, 15, v0
    v_lshlrev_b32 v55, 12, v3
    v_lshlrev_b32 v56, 3, v54
    v_add3_u32 v55, v55, v56, s62
    v_subrev_u32 v56, 1024, v55
    v_subrev_u32 v57, 2048, v55
    v_subrev_u32 v58, 3072, v55
    v_lshlrev_b32 v59, 5, v54
    s_lshl_b32 s63, s12, 9
    v_add_u32 v59, s63, v59
    s_waitcnt lgkmcnt(0)
    s_mov_b32 s44, s4
    s_mov_b32 s45, s5
    s_mov_b32 s46, 2097152
    s_mov_b32 s47, 0x20000
    s_mov_b32 s48, s6
    s_mov_b32 s49, s7
    s_mov_b32 s50, 2097152
    s_mov_b32 s51, 0x20000
    s_mov_b32 s52, s8
    s_mov_b32 s53, s9
    s_mov_b32 s54, 2097152
    s_mov_b32 s55, 0x20000
    buffer_load_dwordx2 v[12:13], v58, s[48:51], 0 offen
    buffer_load_dwordx2 v[14:15], v57, s[48:51], 0 offen
    buffer_load_dwordx2 v[16:17], v56, s[48:51], 0 offen
    buffer_load_dwordx2 v[18:19], v55, s[48:51], 0 offen offset:0
    buffer_load_dwordx2 v[20:21], v55, s[48:51], 0 offen offset:1024
    buffer_load_dwordx2 v[22:23], v55, s[48:51], 0 offen offset:2048
    buffer_load_dwordx2 v[24:25], v55, s[48:51], 0 offen offset:3072
    global_load_dwordx4 v[34:37], v59, s[10:11]
    global_load_dwordx4 v[38:41], v59, s[10:11] offset:16
    buffer_load_dwordx2 v[26:27], v55, s[52:55], 0 offen offset:0
    buffer_load_dwordx2 v[28:29], v55, s[52:55], 0 offen offset:1024
    buffer_load_dwordx2 v[30:31], v55, s[52:55], 0 offen offset:2048
    buffer_load_dwordx2 v[32:33], v55, s[52:55], 0 offen offset:3072
    buffer_load_dwordx2 v[4:5], v55, s[44:47], 0 offen offset:0
    buffer_load_dwordx2 v[6:7], v55, s[44:47], 0 offen offset:1024
    buffer_load_dwordx2 v[8:9], v55, s[44:47], 0 offen offset:2048
    buffer_load_dwordx2 v[10:11], v55, s[44:47], 0 offen offset:3072
    s_load_dword s68, s[42:43], s66
    s_load_dword s69, s[30:31], s66
    v_lshlrev_b32 v60, 1, v3
    v_sub_u32 v60, 30, v60
    v_lshrrev_b32 v61, 2, v60
    v_and_b32 v62, 7, v54
    v_xor_b32 v61, v61, v62
    v_lshlrev_b32 v61, 4, v61
    v_and_b32 v60, 3, v60
    v_lshl_add_u32 v61, v60, 2, v61
    v_lshl_add_u32 v42, v54, 9, v61
    v_add_u32 v42, 33280, v42
    v_bfe_u32 v60, v0, 3, 5
    v_and_b32 v61, 7, v0
    v_lshrrev_b32 v62, 2, v60
    v_xor_b32 v62, v61, v62
    v_lshlrev_b32 v62, 4, v62
    v_lshl_add_u32 v43, v60, 7, v62
    v_add_u32 v43, 33280, v43
    v_lshlrev_b32 v60, 12, v60
    v_lshl_add_u32 v44, v61, 4, v60
    s_lshl_b32 s61, s12, 18
    s_lshl_b32 s3, s13, 7
    s_sub_u32 s61, s61, s3
    s_add_u32 s61, s61, 3968
    v_add_u32 v44, s61, v44
    v_add_u32 v45, 0x20000, v44
    s_add_u32 s70, s34, 0
    s_addc_u32 s71, s35, 0
    s_add_u32 s72, s34, 2097152
    s_addc_u32 s73, s35, 0
    s_lshl_b32 s61, s15, 13
    s_add_u32 s56, s40, s61
    s_addc_u32 s57, s41, 0
    s_mov_b32 s58, 8192
    s_mov_b32 s59, 0x20000
    v_and_b32 v46, 255, v0
    v_lshlrev_b32 v46, 4, v46
    v_add_u32 v47, 4096, v46
    v_add_u32 v48, 32, v46
    v_add_u32 v49, 16640, v48
    v_and_b32 v206, 255, v0
    v_lshlrev_b32 v206, 3, v206
    v_lshrrev_b32 v207, 8, v0
    v_mul_u32_u24 v207, 1536, v207
    v_add_u32 v207, 136192, v207
    v_mov_b32 v208, 127
    v_add_u32 v209, 0, v206
    v_add_u32 v210, 1, v206
    v_cvt_f32_u32 v211, v209
    v_cvt_f32_u32 v212, v210
    v_cvt_pk_bf16_f32 v211, v211, v212
    v_and_b32 v212, 0xffff, v211
    v_lshrrev_b32 v211, 16, v211
    v_subrev_u32 v212, 17024, v212
    v_subrev_u32 v211, 17024, v211
    v_med3_i32 v212, v209, v208, v212
    v_med3_i32 v211, v210, v208, v211
    v_lshl_add_u32 v140, v212, 1, v207
    v_lshl_add_u32 v141, v211, 1, v207
    v_add_u32 v209, 2, v206
    v_add_u32 v210, 3, v206
    v_cvt_f32_u32 v211, v209
    v_cvt_f32_u32 v212, v210
    v_cvt_pk_bf16_f32 v211, v211, v212
    v_and_b32 v212, 0xffff, v211
    v_lshrrev_b32 v211, 16, v211
    v_subrev_u32 v212, 17024, v212
    v_subrev_u32 v211, 17024, v211
    v_med3_i32 v212, v209, v208, v212
    v_med3_i32 v211, v210, v208, v211
    v_lshl_add_u32 v142, v212, 1, v207
    v_lshl_add_u32 v143, v211, 1, v207
    v_add_u32 v209, 4, v206
    v_add_u32 v210, 5, v206
    v_cvt_f32_u32 v211, v209
    v_cvt_f32_u32 v212, v210
    v_cvt_pk_bf16_f32 v211, v211, v212
    v_and_b32 v212, 0xffff, v211
    v_lshrrev_b32 v211, 16, v211
    v_subrev_u32 v212, 17024, v212
    v_subrev_u32 v211, 17024, v211
    v_med3_i32 v212, v209, v208, v212
    v_med3_i32 v211, v210, v208, v211
    v_lshl_add_u32 v144, v212, 1, v207
    v_lshl_add_u32 v145, v211, 1, v207
    v_add_u32 v209, 6, v206
    v_add_u32 v210, 7, v206
    v_cvt_f32_u32 v211, v209
    v_cvt_f32_u32 v212, v210
    v_cvt_pk_bf16_f32 v211, v211, v212
    v_and_b32 v212, 0xffff, v211
    v_lshrrev_b32 v211, 16, v211
    v_subrev_u32 v212, 17024, v212
    v_subrev_u32 v211, 17024, v211
    v_med3_i32 v212, v209, v208, v212
    v_med3_i32 v211, v210, v208, v211
    v_lshl_add_u32 v146, v212, 1, v207
    v_lshl_add_u32 v147, v211, 1, v207
    v_add_u32 v209, 8, v206
    v_add_u32 v210, 9, v206
    v_cvt_f32_u32 v211, v209
    v_cvt_f32_u32 v212, v210
    v_cvt_pk_bf16_f32 v211, v211, v212
    v_and_b32 v212, 0xffff, v211
    v_lshrrev_b32 v211, 16, v211
    v_subrev_u32 v212, 17024, v212
    v_subrev_u32 v211, 17024, v211
    v_med3_i32 v212, v209, v208, v212
    v_med3_i32 v211, v210, v208, v211
    v_lshl_add_u32 v148, v212, 1, v207
    v_lshl_add_u32 v149, v211, 1, v207
    v_add_u32 v209, 10, v206
    v_add_u32 v210, 11, v206
    v_cvt_f32_u32 v211, v209
    v_cvt_f32_u32 v212, v210
    v_cvt_pk_bf16_f32 v211, v211, v212
    v_and_b32 v212, 0xffff, v211
    v_lshrrev_b32 v211, 16, v211
    v_subrev_u32 v212, 17024, v212
    v_subrev_u32 v211, 17024, v211
    v_med3_i32 v212, v209, v208, v212
    v_med3_i32 v211, v210, v208, v211
    v_lshl_add_u32 v150, v212, 1, v207
    v_lshl_add_u32 v151, v211, 1, v207
    v_lshrrev_b32 v210, 8, v0
    v_mul_u32_u24 v210, 16640, v210
    v_and_b32 v211, 255, v0
    v_lshl_add_u32 v210, v211, 4, v210
    v_add_u32 v52, 33312, v210
    s_mov_b32 s62, 0x05040100
    s_mov_b32 s63, 0x07060302
    s_waitcnt vmcnt(10)
    v_lshlrev_b32 v60, 16, v12
    v_and_b32 v61, 0xffff0000, v12
    v_lshlrev_b32 v62, 16, v13
    v_and_b32 v63, 0xffff0000, v13
    v_lshlrev_b32 v64, 16, v14
    v_and_b32 v65, 0xffff0000, v14
    v_lshlrev_b32 v66, 16, v15
    v_and_b32 v67, 0xffff0000, v15
    v_lshlrev_b32 v68, 16, v16
    v_and_b32 v69, 0xffff0000, v16
    v_lshlrev_b32 v70, 16, v17
    v_and_b32 v71, 0xffff0000, v17
    v_lshlrev_b32 v72, 16, v18
    v_and_b32 v73, 0xffff0000, v18
    v_lshlrev_b32 v74, 16, v19
    v_and_b32 v75, 0xffff0000, v19
    v_lshlrev_b32 v76, 16, v20
    v_and_b32 v77, 0xffff0000, v20
    v_lshlrev_b32 v78, 16, v21
    v_and_b32 v79, 0xffff0000, v21
    v_lshlrev_b32 v80, 16, v22
    v_and_b32 v81, 0xffff0000, v22
    v_lshlrev_b32 v82, 16, v23
    v_and_b32 v83, 0xffff0000, v23
    v_lshlrev_b32 v84, 16, v24
    v_and_b32 v85, 0xffff0000, v24
    v_lshlrev_b32 v86, 16, v25
    v_and_b32 v87, 0xffff0000, v25
    s_waitcnt vmcnt(8)
    v_lshlrev_b32 v88, 16, v34
    v_lshlrev_b32 v89, 16, v36
    v_and_b32 v92, 0xffff0000, v34
    v_and_b32 v93, 0xffff0000, v36
    v_lshlrev_b32 v96, 16, v35
    v_lshlrev_b32 v97, 16, v37
    v_and_b32 v100, 0xffff0000, v35
    v_and_b32 v101, 0xffff0000, v37
    v_lshlrev_b32 v90, 16, v38
    v_lshlrev_b32 v91, 16, v40
    v_and_b32 v94, 0xffff0000, v38
    v_and_b32 v95, 0xffff0000, v40
    v_lshlrev_b32 v98, 16, v39
    v_lshlrev_b32 v99, 16, v41
    v_and_b32 v102, 0xffff0000, v39
    v_and_b32 v103, 0xffff0000, v41
    v_pk_mul_f32 v[104:105], v[60:61], v[100:101]
    v_pk_mul_f32 v[106:107], v[62:63], v[102:103]
    v_pk_mul_f32 v[108:109], v[64:65], v[100:101]
    v_pk_mul_f32 v[110:111], v[66:67], v[102:103]
    v_pk_mul_f32 v[112:113], v[68:69], v[100:101]
    v_pk_mul_f32 v[114:115], v[70:71], v[102:103]
    v_pk_mul_f32 v[116:117], v[72:73], v[100:101]
    v_pk_mul_f32 v[118:119], v[74:75], v[102:103]
    v_pk_fma_f32 v[104:105], v[64:65], v[96:97], v[104:105]
    v_pk_fma_f32 v[106:107], v[66:67], v[98:99], v[106:107]
    v_pk_fma_f32 v[108:109], v[68:69], v[96:97], v[108:109]
    v_pk_fma_f32 v[110:111], v[70:71], v[98:99], v[110:111]
    v_pk_fma_f32 v[112:113], v[72:73], v[96:97], v[112:113]
    v_pk_fma_f32 v[114:115], v[74:75], v[98:99], v[114:115]
    v_pk_fma_f32 v[116:117], v[76:77], v[96:97], v[116:117]
    v_pk_fma_f32 v[118:119], v[78:79], v[98:99], v[118:119]
    v_pk_fma_f32 v[104:105], v[68:69], v[92:93], v[104:105]
    v_pk_fma_f32 v[106:107], v[70:71], v[94:95], v[106:107]
    v_pk_fma_f32 v[108:109], v[72:73], v[92:93], v[108:109]
    v_pk_fma_f32 v[110:111], v[74:75], v[94:95], v[110:111]
    v_pk_fma_f32 v[112:113], v[76:77], v[92:93], v[112:113]
    v_pk_fma_f32 v[114:115], v[78:79], v[94:95], v[114:115]
    v_pk_fma_f32 v[116:117], v[80:81], v[92:93], v[116:117]
    v_pk_fma_f32 v[118:119], v[82:83], v[94:95], v[118:119]
    v_pk_fma_f32 v[104:105], v[72:73], v[88:89], v[104:105]
    v_pk_fma_f32 v[106:107], v[74:75], v[90:91], v[106:107]
    v_pk_fma_f32 v[108:109], v[76:77], v[88:89], v[108:109]
    v_pk_fma_f32 v[110:111], v[78:79], v[90:91], v[110:111]
    v_pk_fma_f32 v[112:113], v[80:81], v[88:89], v[112:113]
    v_pk_fma_f32 v[114:115], v[82:83], v[90:91], v[114:115]
    v_pk_fma_f32 v[116:117], v[84:85], v[88:89], v[116:117]
    v_pk_fma_f32 v[118:119], v[86:87], v[90:91], v[118:119]
    s_waitcnt vmcnt(4)
    v_lshlrev_b32 v120, 16, v26
    v_and_b32 v121, 0xffff0000, v26
    v_lshlrev_b32 v122, 16, v27
    v_and_b32 v123, 0xffff0000, v27
    v_lshlrev_b32 v124, 16, v28
    v_and_b32 v125, 0xffff0000, v28
    v_lshlrev_b32 v126, 16, v29
    v_and_b32 v127, 0xffff0000, v29
    v_lshlrev_b32 v128, 16, v30
    v_and_b32 v129, 0xffff0000, v30
    v_lshlrev_b32 v130, 16, v31
    v_and_b32 v131, 0xffff0000, v31
    v_lshlrev_b32 v132, 16, v32
    v_and_b32 v133, 0xffff0000, v32
    v_lshlrev_b32 v134, 16, v33
    v_and_b32 v135, 0xffff0000, v33
    v_pk_mul_f32 v[104:105], v[104:105], v[120:121]
    v_pk_mul_f32 v[106:107], v[106:107], v[122:123]
    v_pk_mul_f32 v[108:109], v[108:109], v[124:125]
    v_pk_mul_f32 v[110:111], v[110:111], v[126:127]
    v_pk_mul_f32 v[112:113], v[112:113], v[128:129]
    v_pk_mul_f32 v[114:115], v[114:115], v[130:131]
    v_pk_mul_f32 v[116:117], v[116:117], v[132:133]
    v_pk_mul_f32 v[118:119], v[118:119], v[134:135]
    v_cvt_pk_bf16_f32 v60, v116, v112
    v_cvt_pk_bf16_f32 v61, v108, v104
    v_cvt_pk_bf16_f32 v62, v117, v113
    v_cvt_pk_bf16_f32 v63, v109, v105
    v_cvt_pk_bf16_f32 v64, v118, v114
    v_cvt_pk_bf16_f32 v65, v110, v106
    v_cvt_pk_bf16_f32 v66, v119, v115
    v_cvt_pk_bf16_f32 v67, v111, v107
    ds_write_b64 v42, v[60:61] offset:0
    ds_write_b64 v42, v[62:63] offset:128
    ds_write_b64 v42, v[64:65] offset:256
    ds_write_b64 v42, v[66:67] offset:384
    s_waitcnt vmcnt(0)
    v_perm_b32 v68, v8, v10, s62
    v_perm_b32 v69, v4, v6, s62
    v_perm_b32 v70, v8, v10, s63
    v_perm_b32 v71, v4, v6, s63
    v_perm_b32 v72, v9, v11, s62
    v_perm_b32 v73, v5, v7, s62
    v_perm_b32 v74, v9, v11, s63
    v_perm_b32 v75, v5, v7, s63
    ds_write_b64 v42, v[68:69] offset:8192
    ds_write_b64 v42, v[70:71] offset:8320
    ds_write_b64 v42, v[72:73] offset:8448
    ds_write_b64 v42, v[74:75] offset:8576
    s_waitcnt lgkmcnt(0)
    s_barrier
    ds_read_b128 v[112:115], v43
    ds_read_b128 v[116:119], v43 offset:8192
    ds_read_b128 v[120:123], v43 offset:4096
    ds_read_b128 v[124:127], v43 offset:12288
    s_waitcnt lgkmcnt(3)
    global_store_dwordx4 v44, v[112:115], s[70:71] sc1
    s_waitcnt lgkmcnt(2)
    global_store_dwordx4 v44, v[116:119], s[72:73] sc1
    s_waitcnt lgkmcnt(1)
    global_store_dwordx4 v45, v[120:123], s[70:71] sc1
    s_waitcnt lgkmcnt(0)
    global_store_dwordx4 v45, v[124:127], s[72:73] sc1
    buffer_load_dwordx4 v[20:23], v46, s[56:59], 0 offen
    buffer_load_dwordx2 v[24:25], v46, s[56:59], 0 offen offset:16
    buffer_load_dwordx4 v[32:35], v47, s[56:59], 0 offen
    buffer_load_dwordx2 v[36:37], v47, s[56:59], 0 offen offset:16
    s_branch L_front_done
L_Tfront:
    s_memrealtime s[70:71]
    s_and_b32 s64, s14, 1
    s_lshr_b32 s65, s14, 1
    v_mov_b32 v40, 0
    v_mov_b32 v41, 0
    v_mov_b32 v42, 0
    v_mov_b32 v43, 0
    v_mov_b32 v44, 0
    v_mov_b32 v45, 0
    v_mov_b32 v46, 0
    v_mov_b32 v47, 0
    v_mov_b32 v48, 0
    v_mov_b32 v49, 0
    s_lshl_b32 s61, s15, 1
    s_add_u32 s61, s61, s64
    s_lshl_b32 s61, s61, 8
    s_lshl_b32 s3, s65, 7
    v_lshlrev_b32 v68, 1, v2
    v_add_u32 v69, s61, v68
    v_add_u32 v68, s3, v69
    v_xor_b32 v69, 128, v68
    s_lshl_b32 s60, s2, 3
    s_lshl_b32 s3, s14, 1
    s_add_u32 s60, s60, s3
    s_lshl_b32 s3, s60, 10
    v_add_u32 v54, s3, v53
    s_waitcnt lgkmcnt(0)
    s_load_dword s67, s[28:29], s66
    global_load_short_d16_hi v40, v68, s[16:17]
    global_load_short_d16_hi v41, v68, s[18:19]
    global_load_short_d16_hi v42, v68, s[20:21]
    global_load_short_d16_hi v43, v68, s[22:23]
    global_load_short_d16_hi v44, v68, s[24:25]
    global_load_short_d16_hi v45, v68, s[26:27]
    global_load_short_d16_hi v46, v69, s[20:21]
    global_load_short_d16_hi v47, v69, s[22:23]
    global_load_short_d16_hi v48, v69, s[24:25]
    global_load_short_d16_hi v49, v69, s[26:27]
    s_or_b32 s3, s2, s14
    s_cmp_lg_u32 s3, 0
    s_cbranch_scc1 L_nononce
    s_memrealtime s[56:57]
    v_mov_b32 v136, 0
    s_waitcnt lgkmcnt(0)
    s_or_b32 s56, s56, 1
    v_mov_b32 v137, s56
    s_mov_b64 exec, 1
    global_store_dword v136, v137, s[38:39] sc1
    s_mov_b64 exec, -1
L_nononce:
    v_and_b32 v206, 255, v0
    v_lshlrev_b32 v206, 3, v206
    v_lshrrev_b32 v207, 8, v0
    v_mul_u32_u24 v207, 1536, v207
    v_add_u32 v207, 136192, v207
    v_mov_b32 v208, 127
    v_add_u32 v209, 0, v206
    v_add_u32 v210, 1, v206
    v_cvt_f32_u32 v211, v209
    v_cvt_f32_u32 v212, v210
    v_cvt_pk_bf16_f32 v211, v211, v212
    v_and_b32 v212, 0xffff, v211
    v_lshrrev_b32 v211, 16, v211
    v_subrev_u32 v212, 17024, v212
    v_subrev_u32 v211, 17024, v211
    v_med3_i32 v212, v209, v208, v212
    v_med3_i32 v211, v210, v208, v211
    v_lshl_add_u32 v140, v212, 1, v207
    v_lshl_add_u32 v141, v211, 1, v207
    v_add_u32 v209, 2, v206
    v_add_u32 v210, 3, v206
    v_cvt_f32_u32 v211, v209
    v_cvt_f32_u32 v212, v210
    v_cvt_pk_bf16_f32 v211, v211, v212
    v_and_b32 v212, 0xffff, v211
    v_lshrrev_b32 v211, 16, v211
    v_subrev_u32 v212, 17024, v212
    v_subrev_u32 v211, 17024, v211
    v_med3_i32 v212, v209, v208, v212
    v_med3_i32 v211, v210, v208, v211
    v_lshl_add_u32 v142, v212, 1, v207
    v_lshl_add_u32 v143, v211, 1, v207
    v_add_u32 v209, 4, v206
    v_add_u32 v210, 5, v206
    v_cvt_f32_u32 v211, v209
    v_cvt_f32_u32 v212, v210
    v_cvt_pk_bf16_f32 v211, v211, v212
    v_and_b32 v212, 0xffff, v211
    v_lshrrev_b32 v211, 16, v211
    v_subrev_u32 v212, 17024, v212
    v_subrev_u32 v211, 17024, v211
    v_med3_i32 v212, v209, v208, v212
    v_med3_i32 v211, v210, v208, v211
    v_lshl_add_u32 v144, v212, 1, v207
    v_lshl_add_u32 v145, v211, 1, v207
    v_add_u32 v209, 6, v206
    v_add_u32 v210, 7, v206
    v_cvt_f32_u32 v211, v209
    v_cvt_f32_u32 v212, v210
    v_cvt_pk_bf16_f32 v211, v211, v212
    v_and_b32 v212, 0xffff, v211
    v_lshrrev_b32 v211, 16, v211
    v_subrev_u32 v212, 17024, v212
    v_subrev_u32 v211, 17024, v211
    v_med3_i32 v212, v209, v208, v212
    v_med3_i32 v211, v210, v208, v211
    v_lshl_add_u32 v146, v212, 1, v207
    v_lshl_add_u32 v147, v211, 1, v207
    v_add_u32 v209, 8, v206
    v_add_u32 v210, 9, v206
    v_cvt_f32_u32 v211, v209
    v_cvt_f32_u32 v212, v210
    v_cvt_pk_bf16_f32 v211, v211, v212
    v_and_b32 v212, 0xffff, v211
    v_lshrrev_b32 v211, 16, v211
    v_subrev_u32 v212, 17024, v212
    v_subrev_u32 v211, 17024, v211
    v_med3_i32 v212, v209, v208, v212
    v_med3_i32 v211, v210, v208, v211
    v_lshl_add_u32 v148, v212, 1, v207
    v_lshl_add_u32 v149, v211, 1, v207
    v_add_u32 v209, 10, v206
    v_add_u32 v210, 11, v206
    v_cvt_f32_u32 v211, v209
    v_cvt_f32_u32 v212, v210
    v_cvt_pk_bf16_f32 v211, v211, v212
    v_and_b32 v212, 0xffff, v211
    v_lshrrev_b32 v211, 16, v211
    v_subrev_u32 v212, 17024, v212
    v_subrev_u32 v211, 17024, v211
    v_med3_i32 v212, v209, v208, v212
    v_med3_i32 v211, v210, v208, v211
    v_lshl_add_u32 v150, v212, 1, v207
    v_lshl_add_u32 v151, v211, 1, v207
    v_lshrrev_b32 v210, 8, v0
    v_mul_u32_u24 v210, 16640, v210
    v_and_b32 v211, 255, v0
    v_lshl_add_u32 v210, v211, 4, v210
    v_add_u32 v52, 33312, v210
    s_waitcnt vmcnt(0) lgkmcnt(0)
    s_cmp_lg_u32 s14, 1
    s_cbranch_scc1 L_nn0
    v_mov_b32 v136, 0
    global_load_dword v137, v136, s[38:39] sc1
L_nn0:
    s_lshl_b32 s3, s67, 16
    s_and_b32 s61, s67, 0xffff0000
    s_cmp_eq_u32 s64, 0
    s_cselect_b32 s3, s3, s61
    v_mov_b32 v60, s3
    v_mul_f32 v61, 0x3fb8aa3b, v60
    s_mov_b32 s61, 0x3fb8aa3b
    v_fma_f32 v62, v60, s61, -v61
    v_mov_b32 v63, 0x32a5705f
    v_fmac_f32 v62, v60, v63
    v_exp_f32 v61, v61
    v_mul_f32 v62, 0x3f317218, v62
    v_fma_f32 v61, v61, v62, v61
    v_cvt_pk_bf16_f32 v61, v61, v61
    v_and_b32 v61, 0xffff0000, v61
    v_mul_f32 v62, v61, v40
    v_mul_f32 v63, v61, v41
    v_mul_f32 v62, 0x3fb8aa3b, v62
    v_mul_f32 v63, 0.15915494, v63
    v_mul_f32 v68, v61, v42
    v_mul_f32 v69, v61, v43
    v_xor_b32 v70, 0x80000000, v69
    v_mul_f32 v64, v44, v68
    v_mul_f32 v65, v44, v69
    v_fmac_f32 v64, v45, v70
    v_fmac_f32 v65, v45, v68
    v_mul_f32 v68, v61, v46
    v_mul_f32 v69, v61, v47
    v_xor_b32 v70, 0x80000000, v69
    v_mul_f32 v66, v48, v68
    v_mul_f32 v67, v48, v69
    v_fmac_f32 v66, v49, v70
    v_fmac_f32 v67, v49, v68
    v_max_f32 v68, |v64|, |v65|
    v_max3_f32 v68, |v66|, |v67|, v68
    v_mul_f32 v70, 0x43000000, v62
    v_mul_f32 v71, 0x43000000, v63
    v_exp_f32 v70, v70
    v_fract_f32 v71, v71
    v_cos_f32 v74, v71
    v_sin_f32 v75, v71
    v_mul_f32 v74, v74, v70
    v_mul_f32 v75, v75, v70
    s_nop 1
    v_max_f32_dpp v68, v68, v68 row_shr:1 row_mask:0xf bank_mask:0xf bound_ctrl:0
    s_nop 1
    v_max_f32_dpp v68, v68, v68 row_shr:2 row_mask:0xf bank_mask:0xf bound_ctrl:0
    s_nop 1
    v_max_f32_dpp v68, v68, v68 row_shr:4 row_mask:0xf bank_mask:0xf bound_ctrl:0
    s_nop 1
    v_max_f32_dpp v68, v68, v68 row_shr:8 row_mask:0xf bank_mask:0xf bound_ctrl:0
    s_nop 1
    v_max_f32_dpp v68, v68, v68 row_bcast:15 row_mask:0xa bank_mask:0xf
    s_nop 1
    v_max_f32_dpp v68, v68, v68 row_bcast:31 row_mask:0xc bank_mask:0xf
    v_xor_b32 v76, 0x80000000, v75
    v_readlane_b32 s74, v68, 63
    s_mul_i32 s75, s64, 34816
    s_max_u32 s74, s74, 0x0da24260
    v_mov_b32 v68, s74
    v_rcp_f32 v69, v68
    s_add_u32 s75, s75, 66560
    s_lshl_b32 s3, s65, 8
    s_add_u32 s3, s3, s75
    v_mul_f32 v64, v64, v69
    v_mul_f32 v65, v65, v69
    v_lshlrev_b32 v72, 2, v2
    v_add_u32 v72, s3, v72
    s_lshl_b32 s3, s64, 2
    s_add_u32 s3, s3, 139268
    v_mov_b32 v69, s3
    ds_write_b32 v69, v68
    v_mul_f32 v70, 0x41000000, v62
    v_mul_f32 v71, 0x41000000, v63
    v_exp_f32 v70, v70
    v_fract_f32 v71, v71
    v_cos_f32 v78, v71
    v_sin_f32 v79, v71
    v_mul_f32 v78, v78, v70
    v_mul_f32 v79, v79, v70
    v_xor_b32 v80, 0x80000000, v79
    v_mul_f32 v70, 0x3f800000, v62
    v_mul_f32 v71, 0x3f800000, v63
    v_exp_f32 v70, v70
    v_fract_f32 v71, v71
    v_cos_f32 v100, v71
    v_sin_f32 v101, v71
    v_mul_f32 v100, v100, v70
    v_mul_f32 v101, v101, v70
    v_xor_b32 v102, 0x80000000, v101
    v_mul_f32 v104, v100, v100
    v_mul_f32 v105, v100, v101
    v_fmac_f32 v104, v101, v102
    v_fmac_f32 v105, v101, v100
    v_xor_b32 v106, 0x80000000, v105
    v_mul_f32 v108, v104, v100
    v_mul_f32 v109, v104, v101
    v_fmac_f32 v108, v105, v102
    v_fmac_f32 v109, v105, v100
    v_xor_b32 v110, 0x80000000, v109
    v_mul_f32 v112, v104, v104
    v_mul_f32 v113, v104, v105
    v_fmac_f32 v112, v105, v106
    v_fmac_f32 v113, v105, v104
    v_xor_b32 v114, 0x80000000, v113
    v_mul_f32 v116, v112, v100
    v_mul_f32 v117, v112, v101
    v_fmac_f32 v116, v113, v102
    v_fmac_f32 v117, v113, v100
    v_xor_b32 v118, 0x80000000, v117
    v_mul_f32 v120, v112, v104
    v_mul_f32 v121, v112, v105
    v_fmac_f32 v120, v113, v106
    v_fmac_f32 v121, v113, v104
    v_xor_b32 v122, 0x80000000, v121
    v_mul_f32 v124, v112, v108
    v_mul_f32 v125, v112, v109
    v_fmac_f32 v124, v113, v110
    v_fmac_f32 v125, v113, v108
    v_xor_b32 v126, 0x80000000, v125
    v_mov_b32 v82, 1.0
    v_mov_b32 v83, 0
    v_cvt_pk_f16_f32 v73, v82, v83
    ds_write_b32 v72, v73 offset:26112
    v_cvt_pk_f16_f32 v77, v78, v79
    ds_write_b32 v72, v77 offset:26656
    v_cvt_pk_f16_f32 v73, v64, -v65
    ds_write_b32 v72, v73 offset:0
    v_mul_f32 v90, v64, v100
    v_mul_f32 v91, v64, v101
    v_fmac_f32 v90, v65, v102
    v_fmac_f32 v91, v65, v100
    v_cvt_pk_f16_f32 v94, v90, -v91
    ds_write_b32 v72, v94 offset:544
    v_mul_f32 v92, v64, v104
    v_mul_f32 v93, v64, v105
    v_fmac_f32 v92, v65, v106
    v_fmac_f32 v93, v65, v104
    v_cvt_pk_f16_f32 v95, v92, -v93
    ds_write_b32 v72, v95 offset:1088
    v_mul_f32 v90, v64, v108
    v_mul_f32 v91, v64, v109
    v_fmac_f32 v90, v65, v110
    v_fmac_f32 v91, v65, v108
    v_cvt_pk_f16_f32 v94, v90, -v91
    ds_write_b32 v72, v94 offset:1632
    v_mul_f32 v92, v64, v112
    v_mul_f32 v93, v64, v113
    v_fmac_f32 v92, v65, v114
    v_fmac_f32 v93, v65, v112
    v_cvt_pk_f16_f32 v95, v92, -v93
    ds_write_b32 v72, v95 offset:2176
    v_mul_f32 v90, v64, v116
    v_mul_f32 v91, v64, v117
    v_fmac_f32 v90, v65, v118
    v_fmac_f32 v91, v65, v116
    v_cvt_pk_f16_f32 v94, v90, -v91
    ds_write_b32 v72, v94 offset:2720
    v_mul_f32 v92, v64, v120
    v_mul_f32 v93, v64, v121
    v_fmac_f32 v92, v65, v122
    v_fmac_f32 v93, v65, v120
    v_cvt_pk_f16_f32 v95, v92, -v93
    ds_write_b32 v72, v95 offset:3264
    v_mul_f32 v90, v64, v124
    v_mul_f32 v91, v64, v125
    v_fmac_f32 v90, v65, v126
    v_fmac_f32 v91, v65, v124
    v_cvt_pk_f16_f32 v94, v90, -v91
    ds_write_b32 v72, v94 offset:3808
    v_mul_f32 v86, v64, v74
    v_mul_f32 v87, v64, v75
    v_fmac_f32 v86, v65, v76
    v_fmac_f32 v87, v65, v74
    v_mul_f32 v82, v78, v78
    v_mul_f32 v83, v78, v79
    v_fmac_f32 v82, v79, v80
    v_fmac_f32 v83, v79, v78
    v_cvt_pk_f16_f32 v73, v86, -v87
    ds_write_b32 v72, v73 offset:4352
    v_cvt_pk_f16_f32 v77, v82, v83
    ds_write_b32 v72, v77 offset:27200
    v_mul_f32 v92, v86, v100
    v_mul_f32 v93, v86, v101
    v_fmac_f32 v92, v87, v102
    v_fmac_f32 v93, v87, v100
    v_cvt_pk_f16_f32 v95, v92, -v93
    ds_write_b32 v72, v95 offset:4896
    v_mul_f32 v90, v86, v104
    v_mul_f32 v91, v86, v105
    v_fmac_f32 v90, v87, v106
    v_fmac_f32 v91, v87, v104
    v_cvt_pk_f16_f32 v94, v90, -v91
    ds_write_b32 v72, v94 offset:5440
    v_mul_f32 v92, v86, v108
    v_mul_f32 v93, v86, v109
    v_fmac_f32 v92, v87, v110
    v_fmac_f32 v93, v87, v108
    v_cvt_pk_f16_f32 v95, v92, -v93
    ds_write_b32 v72, v95 offset:5984
    v_mul_f32 v90, v86, v112
    v_mul_f32 v91, v86, v113
    v_fmac_f32 v90, v87, v114
    v_fmac_f32 v91, v87, v112
    v_cvt_pk_f16_f32 v94, v90, -v91
    ds_write_b32 v72, v94 offset:6528
    v_mul_f32 v92, v86, v116
    v_mul_f32 v93, v86, v117
    v_fmac_f32 v92, v87, v118
    v_fmac_f32 v93, v87, v116
    v_cvt_pk_f16_f32 v95, v92, -v93
    ds_write_b32 v72, v95 offset:7072
    v_mul_f32 v90, v86, v120
    v_mul_f32 v91, v86, v121
    v_fmac_f32 v90, v87, v122
    v_fmac_f32 v91, v87, v120
    v_cvt_pk_f16_f32 v94, v90, -v91
    ds_write_b32 v72, v94 offset:7616
    v_mul_f32 v92, v86, v124
    v_mul_f32 v93, v86, v125
    v_fmac_f32 v92, v87, v126
    v_fmac_f32 v93, v87, v124
    v_cvt_pk_f16_f32 v95, v92, -v93
    ds_write_b32 v72, v95 offset:8160
    v_mul_f32 v88, v86, v74
    v_mul_f32 v89, v86, v75
    v_fmac_f32 v88, v87, v76
    v_fmac_f32 v89, v87, v74
    v_mul_f32 v84, v82, v78
    v_mul_f32 v85, v82, v79
    v_fmac_f32 v84, v83, v80
    v_fmac_f32 v85, v83, v78
    v_cvt_pk_f16_f32 v73, v88, -v89
    ds_write_b32 v72, v73 offset:8704
    v_cvt_pk_f16_f32 v77, v84, v85
    ds_write_b32 v72, v77 offset:27744
    v_mul_f32 v90, v88, v104
    v_mul_f32 v91, v88, v105
    v_fmac_f32 v90, v89, v106
    v_fmac_f32 v91, v89, v104
    v_cvt_pk_f16_f32 v94, v90, -v91
    ds_write_b32 v72, v94 offset:9248
    v_mul_f32 v92, v88, v112
    v_mul_f32 v93, v88, v113
    v_fmac_f32 v92, v89, v114
    v_fmac_f32 v93, v89, v112
    v_cvt_pk_f16_f32 v95, v92, -v93
    ds_write_b32 v72, v95 offset:9792
    v_mul_f32 v90, v88, v120
    v_mul_f32 v91, v88, v121
    v_fmac_f32 v90, v89, v122
    v_fmac_f32 v91, v89, v120
    v_cvt_pk_f16_f32 v94, v90, -v91
    ds_write_b32 v72, v94 offset:10336
    v_mul_f32 v86, v88, v74
    v_mul_f32 v87, v88, v75
    v_fmac_f32 v86, v89, v76
    v_fmac_f32 v87, v89, v74
    v_mul_f32 v82, v84, v78
    v_mul_f32 v83, v84, v79
    v_fmac_f32 v82, v85, v80
    v_fmac_f32 v83, v85, v78
    v_cvt_pk_f16_f32 v73, v86, -v87
    ds_write_b32 v72, v73 offset:10880
    v_cvt_pk_f16_f32 v77, v82, v83
    ds_write_b32 v72, v77 offset:28288
    v_mul_f32 v92, v86, v104
    v_mul_f32 v93, v86, v105
    v_fmac_f32 v92, v87, v106
    v_fmac_f32 v93, v87, v104
    v_cvt_pk_f16_f32 v95, v92, -v93
    ds_write_b32 v72, v95 offset:11424
    v_mul_f32 v90, v86, v112
    v_mul_f32 v91, v86, v113
    v_fmac_f32 v90, v87, v114
    v_fmac_f32 v91, v87, v112
    v_cvt_pk_f16_f32 v94, v90, -v91
    ds_write_b32 v72, v94 offset:11968
    v_mul_f32 v92, v86, v120
    v_mul_f32 v93, v86, v121
    v_fmac_f32 v92, v87, v122
    v_fmac_f32 v93, v87, v120
    v_cvt_pk_f16_f32 v95, v92, -v93
    ds_write_b32 v72, v95 offset:12512
    v_mul_f32 v88, v86, v74
    v_mul_f32 v89, v86, v75
    v_fmac_f32 v88, v87, v76
    v_fmac_f32 v89, v87, v74
    v_mul_f32 v84, v82, v78
    v_mul_f32 v85, v82, v79
    v_fmac_f32 v84, v83, v80
    v_fmac_f32 v85, v83, v78
    v_cvt_pk_f16_f32 v73, v88, -v89
    ds_write_b32 v72, v73 offset:13056
    v_cvt_pk_f16_f32 v77, v84, v85
    ds_write_b32 v72, v77 offset:28832
    v_mul_f32 v90, v88, v112
    v_mul_f32 v91, v88, v113
    v_fmac_f32 v90, v89, v114
    v_fmac_f32 v91, v89, v112
    v_cvt_pk_f16_f32 v94, v90, -v91
    ds_write_b32 v72, v94 offset:13600
    v_mul_f32 v86, v88, v74
    v_mul_f32 v87, v88, v75
    v_fmac_f32 v86, v89, v76
    v_fmac_f32 v87, v89, v74
    v_mul_f32 v82, v84, v78
    v_mul_f32 v83, v84, v79
    v_fmac_f32 v82, v85, v80
    v_fmac_f32 v83, v85, v78
    v_cvt_pk_f16_f32 v73, v86, -v87
    ds_write_b32 v72, v73 offset:14144
    v_cvt_pk_f16_f32 v77, v82, v83
    ds_write_b32 v72, v77 offset:29376
    v_mul_f32 v92, v86, v112
    v_mul_f32 v93, v86, v113
    v_fmac_f32 v92, v87, v114
    v_fmac_f32 v93, v87, v112
    v_cvt_pk_f16_f32 v95, v92, -v93
    ds_write_b32 v72, v95 offset:14688
    v_mul_f32 v88, v86, v74
    v_mul_f32 v89, v86, v75
    v_fmac_f32 v88, v87, v76
    v_fmac_f32 v89, v87, v74
    v_mul_f32 v84, v82, v78
    v_mul_f32 v85, v82, v79
    v_fmac_f32 v84, v83, v80
    v_fmac_f32 v85, v83, v78
    v_cvt_pk_f16_f32 v73, v88, -v89
    ds_write_b32 v72, v73 offset:15232
    v_cvt_pk_f16_f32 v77, v84, v85
    ds_write_b32 v72, v77 offset:29920
    v_mul_f32 v90, v88, v112
    v_mul_f32 v91, v88, v113
    v_fmac_f32 v90, v89, v114
    v_fmac_f32 v91, v89, v112
    v_cvt_pk_f16_f32 v94, v90, -v91
    ds_write_b32 v72, v94 offset:15776
    v_mul_f32 v86, v88, v74
    v_mul_f32 v87, v88, v75
    v_fmac_f32 v86, v89, v76
    v_fmac_f32 v87, v89, v74
    v_mul_f32 v82, v84, v78
    v_mul_f32 v83, v84, v79
    v_fmac_f32 v82, v85, v80
    v_fmac_f32 v83, v85, v78
    v_cvt_pk_f16_f32 v73, v86, -v87
    ds_write_b32 v72, v73 offset:16320
    v_cvt_pk_f16_f32 v77, v82, v83
    ds_write_b32 v72, v77 offset:30464
    v_mul_f32 v92, v86, v112
    v_mul_f32 v93, v86, v113
    v_fmac_f32 v92, v87, v114
    v_fmac_f32 v93, v87, v112
    v_cvt_pk_f16_f32 v95, v92, -v93
    ds_write_b32 v72, v95 offset:16864
    v_mul_f32 v88, v86, v74
    v_mul_f32 v89, v86, v75
    v_fmac_f32 v88, v87, v76
    v_fmac_f32 v89, v87, v74
    v_mul_f32 v84, v82, v78
    v_mul_f32 v85, v82, v79
    v_fmac_f32 v84, v83, v80
    v_fmac_f32 v85, v83, v78
    v_cvt_pk_f16_f32 v73, v88, -v89
    ds_write_b32 v72, v73 offset:17408
    v_cvt_pk_f16_f32 v77, v84, v85
    ds_write_b32 v72, v77 offset:31008
    v_mul_f32 v86, v88, v74
    v_mul_f32 v87, v88, v75
    v_fmac_f32 v86, v89, v76
    v_fmac_f32 v87, v89, v74
    v_mul_f32 v82, v84, v78
    v_mul_f32 v83, v84, v79
    v_fmac_f32 v82, v85, v80
    v_fmac_f32 v83, v85, v78
    v_cvt_pk_f16_f32 v73, v86, -v87
    ds_write_b32 v72, v73 offset:17952
    v_cvt_pk_f16_f32 v77, v82, v83
    ds_write_b32 v72, v77 offset:31552
    v_mul_f32 v88, v86, v74
    v_mul_f32 v89, v86, v75
    v_fmac_f32 v88, v87, v76
    v_fmac_f32 v89, v87, v74
    v_mul_f32 v84, v82, v78
    v_mul_f32 v85, v82, v79
    v_fmac_f32 v84, v83, v80
    v_fmac_f32 v85, v83, v78
    v_cvt_pk_f16_f32 v73, v88, -v89
    ds_write_b32 v72, v73 offset:18496
    v_cvt_pk_f16_f32 v77, v84, v85
    ds_write_b32 v72, v77 offset:32096
    v_mul_f32 v86, v88, v74
    v_mul_f32 v87, v88, v75
    v_fmac_f32 v86, v89, v76
    v_fmac_f32 v87, v89, v74
    v_mul_f32 v82, v84, v78
    v_mul_f32 v83, v84, v79
    v_fmac_f32 v82, v85, v80
    v_fmac_f32 v83, v85, v78
    v_cvt_pk_f16_f32 v73, v86, -v87
    ds_write_b32 v72, v73 offset:19040
    v_cvt_pk_f16_f32 v77, v82, v83
    ds_write_b32 v72, v77 offset:32640
    v_mul_f32 v88, v86, v74
    v_mul_f32 v89, v86, v75
    v_fmac_f32 v88, v87, v76
    v_fmac_f32 v89, v87, v74
    v_mul_f32 v84, v82, v78
    v_mul_f32 v85, v82, v79
    v_fmac_f32 v84, v83, v80
    v_fmac_f32 v85, v83, v78
    v_cvt_pk_f16_f32 v73, v88, -v89
    ds_write_b32 v72, v73 offset:19584
    v_cvt_pk_f16_f32 v77, v84, v85
    ds_write_b32 v72, v77 offset:33184
    v_mul_f32 v86, v88, v74
    v_mul_f32 v87, v88, v75
    v_fmac_f32 v86, v89, v76
    v_fmac_f32 v87, v89, v74
    v_mul_f32 v82, v84, v78
    v_mul_f32 v83, v84, v79
    v_fmac_f32 v82, v85, v80
    v_fmac_f32 v83, v85, v78
    v_cvt_pk_f16_f32 v73, v86, -v87
    ds_write_b32 v72, v73 offset:20128
    v_cvt_pk_f16_f32 v77, v82, v83
    ds_write_b32 v72, v77 offset:33728
    v_mul_f32 v88, v86, v74
    v_mul_f32 v89, v86, v75
    v_fmac_f32 v88, v87, v76
    v_fmac_f32 v89, v87, v74
    v_mul_f32 v84, v82, v78
    v_mul_f32 v85, v82, v79
    v_fmac_f32 v84, v83, v80
    v_fmac_f32 v85, v83, v78
    v_cvt_pk_f16_f32 v73, v88, -v89
    ds_write_b32 v72, v73 offset:20672
    v_cvt_pk_f16_f32 v77, v84, v85
    ds_write_b32 v72, v77 offset:34272
    v_mul_f32 v86, v88, v74
    v_mul_f32 v87, v88, v75
    v_fmac_f32 v86, v89, v76
    v_fmac_f32 v87, v89, v74
    v_cvt_pk_f16_f32 v73, v86, -v87
    ds_write_b32 v72, v73 offset:21216
    v_mul_f32 v88, v86, v74
    v_mul_f32 v89, v86, v75
    v_fmac_f32 v88, v87, v76
    v_fmac_f32 v89, v87, v74
    v_cvt_pk_f16_f32 v73, v88, -v89
    ds_write_b32 v72, v73 offset:21760
    s_cmp_lg_u32 s14, 1
    s_cbranch_scc1 L_nonce_done
    v_mov_b32 v136, 0
    s_mov_b32 s28, 0
    s_waitcnt vmcnt(0)
L_nonce_poll:
    v_readfirstlane_b32 s3, v137
    s_add_u32 s28, s28, 1
    s_cmp_gt_u32 s28, 0x100000
    s_cbranch_scc1 L_nonce_got
    s_cmp_eq_u32 s3, 0
    s_cbranch_scc1 L_nonce_retry
    s_sub_i32 s61, s70, s3
    s_cmp_lt_i32 s61, 500
    s_cbranch_scc1 L_nonce_got
    s_cmp_gt_u32 s28, 24
    s_cbranch_scc1 L_nonce_got
L_nonce_retry:
    global_load_dword v137, v136, s[38:39] sc1
    s_waitcnt vmcnt(0)
    s_branch L_nonce_poll
L_nonce_got:
    v_mov_b32 v136, 139264
    ds_write_b32 v136, v137
L_nonce_done:
    s_waitcnt lgkmcnt(0)
    s_barrier
    global_load_dwordx4 v[4:7], v54, s[4:5]
    global_load_dwordx4 v[8:11], v54, s[4:5] offset:1024
    global_load_dwordx4 v[12:15], v53, s[32:33]
L_front_done:
    v_mov_b32 v135, 139264
    ds_read_b96 v[132:134], v135
    s_cmp_ge_u32 s14, 6
    s_cbranch_scc1 L_jobdone
    s_and_b32 s64, s14, 1
    s_lshr_b32 s3, s14, 1
    s_mul_i32 s75, s64, 34816
    s_add_u32 s75, s75, 66560
    v_and_b32 v60, 15, v2
    v_lshrrev_b32 v61, 4, v2
    v_mul_u32_u24 v62, 544, v60
    v_lshl_add_u32 v62, v61, 4, v62
    v_add_u32 v62, s75, v62
    s_mul_i32 s61, s3, 8704
    v_add_u32 v63, s61, v62
    ds_read_b128 v[80:83], v63 offset:0
    ds_read_b128 v[168:171], v62 offset:26112
    ds_read_b128 v[84:87], v63 offset:64
    ds_read_b128 v[172:175], v62 offset:26176
    ds_read_b128 v[88:91], v63 offset:128
    ds_read_b128 v[176:179], v62 offset:26240
    ds_read_b128 v[92:95], v63 offset:192
    ds_read_b128 v[180:183], v62 offset:26304
    ds_read_b128 v[96:99], v63 offset:256
    ds_read_b128 v[184:187], v62 offset:26368
    ds_read_b128 v[100:103], v63 offset:320
    ds_read_b128 v[188:191], v62 offset:26432
    ds_read_b128 v[104:107], v63 offset:384
    ds_read_b128 v[192:195], v62 offset:26496
    ds_read_b128 v[108:111], v63 offset:448
    ds_read_b128 v[196:199], v62 offset:26560
    s_waitcnt lgkmcnt(14)
    v_readfirstlane_b32 s74, v133
    v_readfirstlane_b32 s75, v134
    v_mfma_f32_16x16x32_f16 v[64:67], v[80:83], v[168:171], 0
    s_waitcnt lgkmcnt(12)
    v_mfma_f32_16x16x32_f16 v[64:67], v[84:87], v[172:175], v[64:67]
    s_waitcnt lgkmcnt(10)
    v_mfma_f32_16x16x32_f16 v[64:67], v[88:91], v[176:179], v[64:67]
    s_waitcnt lgkmcnt(8)
    v_mfma_f32_16x16x32_f16 v[64:67], v[92:95], v[180:183], v[64:67]
    s_waitcnt lgkmcnt(6)
    v_mfma_f32_16x16x32_f16 v[64:67], v[96:99], v[184:187], v[64:67]
    s_waitcnt lgkmcnt(4)
    v_mfma_f32_16x16x32_f16 v[64:67], v[100:103], v[188:191], v[64:67]
    s_waitcnt lgkmcnt(2)
    v_mfma_f32_16x16x32_f16 v[64:67], v[104:107], v[192:195], v[64:67]
    s_waitcnt lgkmcnt(0)
    v_mfma_f32_16x16x32_f16 v[64:67], v[108:111], v[196:199], v[64:67]
    s_cmp_eq_u32 s64, 0
    s_cselect_b32 s74, s74, s75
    s_mul_i32 s61, s64, 1536
    s_add_u32 s61, s61, 136192
    s_nop 5
    v_mul_f32 v64, s74, v64
    v_mul_f32 v65, s74, v65
    v_mul_f32 v66, s74, v66
    v_mul_f32 v67, s74, v67
    v_cvt_pk_bf16_f32 v68, v64, v65
    v_cvt_pk_bf16_f32 v69, v66, v67
    s_cmp_eq_u32 s3, 1
    s_cbranch_scc1 L_job1
    s_cmp_eq_u32 s3, 2
    s_cbranch_scc1 L_job2
    v_lshrrev_b32 v70, 1, v61
    v_lshlrev_b32 v70, 8, v70
    v_lshl_add_u32 v70, v60, 4, v70
    v_and_b32 v71, 1, v61
    v_lshl_add_u32 v70, v71, 3, v70
    v_add_u32 v70, s61, v70
    ds_write_b64 v70, v[68:69]
    s_branch L_jobdone
L_job1:
    v_lshlrev_b32 v70, 7, v61
    v_lshl_add_u32 v71, v60, 3, v70
    v_lshl_add_u32 v72, v60, 2, v70
    v_cmp_gt_u32 vcc, 2, v61
    v_mov_b32 v73, 64
    s_nop 1
    v_cndmask_b32 v70, v72, v71, vcc
    v_cndmask_b32 v73, v73, 4, vcc
    v_add_u32 v70, s61, v70
    v_add_u32 v73, v70, v73
    ds_write_b32 v70, v68 offset:512
    ds_write_b32 v73, v69 offset:512
    s_branch L_jobdone
L_job2:
    v_lshlrev_b32 v70, 7, v61
    v_lshl_add_u32 v70, v60, 1, v70
    v_add_u32 v70, s61, v70
    ds_write_b16 v70, v68 offset:1024
    ds_write_b16_d16_hi v70, v68 offset:1056
    ds_write_b16 v70, v69 offset:1088
    ds_write_b16_d16_hi v70, v69 offset:1120
L_jobdone:
    s_waitcnt lgkmcnt(0)
    v_readfirstlane_b32 s27, v132
    s_barrier
    ds_read_u16 v60, v140
    ds_read_u16_d16_hi v68, v141
    ds_read_u16 v61, v142
    ds_read_u16_d16_hi v69, v143
    ds_read_u16 v62, v144
    ds_read_u16_d16_hi v70, v145
    ds_read_u16 v63, v146
    ds_read_u16_d16_hi v71, v147
    ds_read_u16 v64, v148
    ds_read_u16_d16_hi v72, v149
    ds_read_u16 v65, v150
    ds_read_u16_d16_hi v73, v151
    s_and_b32 s20, s14, 3
    s_mul_i32 s21, s20, 4608
    s_add_u32 s21, s21, 66560
    s_and_b32 s3, s20, 1
    s_lshl_b32 s61, s15, 1
    s_add_u32 s61, s61, s3
    s_lshl_b32 s61, s61, 12
    s_lshr_b32 s3, s20, 1
    s_cmp_eq_u32 s3, 0
    s_cselect_b32 s3, 0, 2097152
    s_add_u32 s61, s61, s3
    s_lshr_b32 s3, s14, 2
    s_lshl_b32 s3, s3, 11
    s_add_u32 s61, s61, s3
    s_add_u32 s22, s34, s61
    s_addc_u32 s23, s35, 0
    s_add_u32 s24, s21, s3
    s_waitcnt lgkmcnt(0)
    v_and_b32 v68, 0xffff0000, v68
    v_or_b32 v60, v60, v68
    v_and_b32 v69, 0xffff0000, v69
    v_or_b32 v61, v61, v69
    v_and_b32 v70, 0xffff0000, v70
    v_or_b32 v62, v62, v70
    v_and_b32 v71, 0xffff0000, v71
    v_or_b32 v63, v63, v71
    v_and_b32 v72, 0xffff0000, v72
    v_or_b32 v64, v64, v72
    v_and_b32 v73, 0xffff0000, v73
    v_or_b32 v65, v65, v73
    ds_write_b128 v52, v[60:63]
    v_alignbit_b32 v80, v61, v60, 16
    v_alignbit_b32 v81, v62, v61, 16
    v_alignbit_b32 v82, v63, v62, 16
    v_alignbit_b32 v83, v64, v63, 16
    ds_write_b128 v52, v[80:83] offset:4160
    v_mov_b32 v84, v61
    v_mov_b32 v85, v62
    v_mov_b32 v86, v63
    v_mov_b32 v87, v64
    ds_write_b128 v52, v[84:87] offset:8320
    v_alignbit_b32 v88, v62, v61, 16
    v_alignbit_b32 v89, v63, v62, 16
    v_alignbit_b32 v90, v64, v63, 16
    v_alignbit_b32 v91, v65, v64, 16
    ds_write_b128 v52, v[88:91] offset:12480
    s_cmp_lg_u32 s20, 0
    s_cbranch_scc1 L_nofront2
    s_mov_b64 exec, 1
    v_mov_b32 v92, 0
    v_mov_b32 v93, 0
    v_mov_b32 v94, 0
    v_mov_b32 v95, 0
    v_mov_b32 v96, 0
    v_mov_b32 v97, 0
    v_mov_b32 v98, 0
    v_mov_b32 v99, 0
    v_mov_b32 v100, 0
    v_mov_b32 v101, 0
    v_mov_b32 v102, 0
    v_mov_b32 v103, 0
    v_mov_b32 v104, 0
    v_mov_b32 v105, 0
    v_mov_b32 v106, 0
    v_mov_b32 v107, 0
    v_subrev_u32 v108, 32, v52
    v_lshlrev_b32 v99, 16, v60
    v_mov_b32 v103, v60
    v_lshlrev_b32 v106, 16, v60
    v_alignbit_b32 v107, v61, v60, 16
    ds_write_b128 v108, v[92:95] offset:0
    ds_write_b128 v108, v[92:95] offset:4160
    ds_write_b128 v108, v[92:95] offset:8320
    ds_write_b128 v108, v[92:95] offset:12480
    ds_write_b128 v108, v[92:95] offset:16
    ds_write_b128 v108, v[96:99] offset:4176
    ds_write_b128 v108, v[100:103] offset:8336
    ds_write_b128 v108, v[104:107] offset:12496
    s_mov_b64 exec, -1
L_nofront2:
    s_cmp_lt_u32 s14, 4
    s_cbranch_scc1 L_Tmid
    s_lshl_b32 s3, s2, 7
    s_lshl_b32 s61, s14, 2
    s_add_u32 s3, s3, s61
    s_add_u32 s3, s3, 7340016
    v_mov_b32 v134, s3
    v_mov_b32 v135, s27
    s_waitcnt vmcnt(4)
    s_mov_b64 exec, 1
    global_store_dword v134, v135, s[34:35] sc1
    s_mov_b64 exec, -1
    s_waitcnt vmcnt(3)
    ds_write_b128 v48, v[20:23]
    v_alignbit_b32 v112, v21, v20, 16
    v_alignbit_b32 v113, v22, v21, 16
    v_alignbit_b32 v114, v23, v22, 16
    v_alignbit_b32 v115, v24, v23, 16
    ds_write_b128 v48, v[112:115] offset:4160
    v_mov_b32 v116, v21
    v_mov_b32 v117, v22
    v_mov_b32 v118, v23
    v_mov_b32 v119, v24
    ds_write_b128 v48, v[116:119] offset:8320
    v_alignbit_b32 v120, v22, v21, 16
    v_alignbit_b32 v121, v23, v22, 16
    v_alignbit_b32 v122, v24, v23, 16
    v_alignbit_b32 v123, v25, v24, 16
    ds_write_b128 v48, v[120:123] offset:12480
    s_waitcnt vmcnt(1)
    ds_write_b128 v49, v[32:35]
    v_alignbit_b32 v124, v33, v32, 16
    v_alignbit_b32 v125, v34, v33, 16
    v_alignbit_b32 v126, v35, v34, 16
    v_alignbit_b32 v127, v36, v35, 16
    ds_write_b128 v49, v[124:127] offset:4160
    v_mov_b32 v128, v33
    v_mov_b32 v129, v34
    v_mov_b32 v130, v35
    v_mov_b32 v131, v36
    ds_write_b128 v49, v[128:131] offset:8320
    v_alignbit_b32 v132, v34, v33, 16
    v_alignbit_b32 v133, v35, v34, 16
    v_alignbit_b32 v134, v36, v35, 16
    v_alignbit_b32 v135, v37, v36, 16
    ds_write_b128 v49, v[132:135] offset:12480
    s_cmp_lg_u32 s14, 4
    s_cbranch_scc1 L_nofront1
    s_mov_b64 exec, 1
    v_mov_b32 v152, 0
    v_mov_b32 v153, 0
    v_mov_b32 v154, 0
    v_mov_b32 v155, 0
    v_mov_b32 v156, 0
    v_mov_b32 v157, 0
    v_mov_b32 v158, 0
    v_mov_b32 v159, 0
    v_mov_b32 v160, 0
    v_mov_b32 v161, 0
    v_mov_b32 v162, 0
    v_mov_b32 v163, 0
    v_mov_b32 v164, 0
    v_mov_b32 v165, 0
    v_mov_b32 v166, 0
    v_mov_b32 v167, 0
    v_subrev_u32 v168, 32, v48
    v_lshlrev_b32 v159, 16, v20
    v_mov_b32 v163, v20
    v_lshlrev_b32 v166, 16, v20
    v_alignbit_b32 v167, v21, v20, 16
    ds_write_b128 v168, v[152:155] offset:0
    ds_write_b128 v168, v[152:155] offset:4160
    ds_write_b128 v168, v[152:155] offset:8320
    ds_write_b128 v168, v[152:155] offset:12480
    ds_write_b128 v168, v[152:155] offset:16
    ds_write_b128 v168, v[156:159] offset:4176
    ds_write_b128 v168, v[160:163] offset:8336
    ds_write_b128 v168, v[164:167] offset:12496
    v_mov_b32 v172, 0
    v_mov_b32 v173, 0
    v_mov_b32 v174, 0
    v_mov_b32 v175, 0
    v_mov_b32 v176, 0
    v_mov_b32 v177, 0
    v_mov_b32 v178, 0
    v_mov_b32 v179, 0
    v_mov_b32 v180, 0
    v_mov_b32 v181, 0
    v_mov_b32 v182, 0
    v_mov_b32 v183, 0
    v_mov_b32 v184, 0
    v_mov_b32 v185, 0
    v_mov_b32 v186, 0
    v_mov_b32 v187, 0
    v_subrev_u32 v188, 32, v49
    v_lshlrev_b32 v179, 16, v32
    v_mov_b32 v183, v32
    v_lshlrev_b32 v186, 16, v32
    v_alignbit_b32 v187, v33, v32, 16
    ds_write_b128 v188, v[172:175] offset:0
    ds_write_b128 v188, v[172:175] offset:4160
    ds_write_b128 v188, v[172:175] offset:8320
    ds_write_b128 v188, v[172:175] offset:12480
    ds_write_b128 v188, v[172:175] offset:16
    ds_write_b128 v188, v[176:179] offset:4176
    ds_write_b128 v188, v[180:183] offset:8336
    ds_write_b128 v188, v[184:187] offset:12496
    s_mov_b64 exec, -1
L_nofront1:
    s_sub_u32 s26, s14, 4
    v_lshlrev_b32 v67, 8, v2
    v_add_u32 v67, 117760, v67
    v_mov_b32 v72, 0
    s_mov_b32 exec_hi, 0
    ds_write_b32 v67, v72
    s_mov_b64 exec, -1
    s_lshl_b32 s3, s26, 6
    v_add_u32 v10, s3, v2
    v_lshrrev_b32 v11, 4, v10
    v_bfe_u32 v12, v10, 2, 2
    v_lshlrev_b32 v13, 1, v12
    v_xor_b32 v11, v11, v13
    v_lshlrev_b32 v11, 4, v11
    v_lshl_add_u32 v11, v12, 8, v11
    v_and_b32 v12, 3, v10
    v_lshl_add_u32 v11, v12, 2, v11
    v_add_u32 v12, 84992, v11
    v_lshlrev_b32 v13, 3, v10
    v_add_u32 v13, 6291456, v13
    v_lshlrev_b32 v14, 1, v10
    v_sub_u32 v14, 67070, v14
    v_lshlrev_b32 v15, 10, v10
    s_lshl_b32 s3, s15, 2
    v_add_u32 v15, s3, v15
    v_and_b32 v9, 3, v2
    v_lshlrev_b32 v9, 8, v9
    v_add_u32 v9, 117760, v9
    v_add_u32 v1, s24, v53
    v_mov_b32 v7, v53
    v_and_b32 v16, 31, v2
    v_lshlrev_b32 v16, 10, v16
    s_lshl_b32 s3, s12, 7
    s_add_u32 s3, s3, 7340032
    v_add_u32 v16, s3, v16
    s_cmp_lg_u32 s14, 4
    s_cbranch_scc1 L_nopoll0
    s_mov_b32 exec_hi, 0
    global_load_dwordx4 v[100:103], v16, s[34:35] sc1
    s_mov_b64 exec, -1
L_nopoll0:
    s_waitcnt lgkmcnt(0)
    s_branch L_mid_done
L_Tmid:
    s_waitcnt vmcnt(0)
    v_lshlrev_b32 v60, 16, v12
    v_and_b32 v61, 0xffff0000, v12
    v_lshlrev_b32 v62, 16, v13
    v_and_b32 v63, 0xffff0000, v13
    v_lshlrev_b32 v64, 16, v14
    v_and_b32 v65, 0xffff0000, v14
    v_lshlrev_b32 v66, 16, v15
    v_and_b32 v67, 0xffff0000, v15
    v_lshlrev_b32 v68, 16, v4
    v_and_b32 v69, 0xffff0000, v4
    v_lshlrev_b32 v70, 16, v5
    v_and_b32 v71, 0xffff0000, v5
    v_lshlrev_b32 v72, 16, v6
    v_and_b32 v73, 0xffff0000, v6
    v_lshlrev_b32 v74, 16, v7
    v_and_b32 v75, 0xffff0000, v7
    v_lshlrev_b32 v76, 16, v8
    v_and_b32 v77, 0xffff0000, v8
    v_lshlrev_b32 v78, 16, v9
    v_and_b32 v79, 0xffff0000, v9
    v_lshlrev_b32 v80, 16, v10
    v_and_b32 v81, 0xffff0000, v10
    v_lshlrev_b32 v82, 16, v11
    v_and_b32 v83, 0xffff0000, v11
    v_mul_f32 v68, v68, v60
    v_mul_f32 v69, v69, v61
    v_mul_f32 v70, v70, v62
    v_mul_f32 v71, v71, v63
    v_mul_f32 v72, v72, v64
    v_mul_f32 v73, v73, v65
    v_mul_f32 v74, v74, v66
    v_mul_f32 v75, v75, v67
    v_mul_f32 v76, v76, v60
    v_mul_f32 v77, v77, v61
    v_mul_f32 v78, v78, v62
    v_mul_f32 v79, v79, v63
    v_mul_f32 v80, v80, v64
    v_mul_f32 v81, v81, v65
    v_mul_f32 v82, v82, v66
    v_mul_f32 v83, v83, v67
    v_cvt_pk_bf16_f32 v84, v68, v69
    v_lshlrev_b32 v68, 16, v84
    v_and_b32 v69, 0xffff0000, v84
    v_cvt_pk_bf16_f32 v85, v70, v71
    v_lshlrev_b32 v70, 16, v85
    v_and_b32 v71, 0xffff0000, v85
    v_cvt_pk_bf16_f32 v86, v72, v73
    v_lshlrev_b32 v72, 16, v86
    v_and_b32 v73, 0xffff0000, v86
    v_cvt_pk_bf16_f32 v87, v74, v75
    v_lshlrev_b32 v74, 16, v87
    v_and_b32 v75, 0xffff0000, v87
    v_cvt_pk_bf16_f32 v84, v76, v77
    v_lshlrev_b32 v76, 16, v84
    v_and_b32 v77, 0xffff0000, v84
    v_cvt_pk_bf16_f32 v85, v78, v79
    v_lshlrev_b32 v78, 16, v85
    v_and_b32 v79, 0xffff0000, v85
    v_cvt_pk_bf16_f32 v86, v80, v81
    v_lshlrev_b32 v80, 16, v86
    v_and_b32 v81, 0xffff0000, v86
    v_cvt_pk_bf16_f32 v87, v82, v83
    v_lshlrev_b32 v82, 16, v87
    v_and_b32 v83, 0xffff0000, v87
    v_add_f32 v68, v68, v69
    v_add_f32 v70, v70, v71
    v_add_f32 v72, v72, v73
    v_add_f32 v74, v74, v75
    v_add_f32 v68, v68, v70
    v_add_f32 v72, v72, v74
    v_add_f32 v68, v68, v72
    v_add_f32 v76, v76, v77
    v_add_f32 v78, v78, v79
    v_add_f32 v80, v80, v81
    v_add_f32 v82, v82, v83
    v_add_f32 v76, v76, v78
    v_add_f32 v80, v80, v82
    v_add_f32 v76, v76, v80
    s_nop 0
    v_add_f32_dpp v68, v68, v68 row_shr:1 row_mask:0xf bank_mask:0xf bound_ctrl:0
    v_add_f32_dpp v76, v76, v76 row_shr:1 row_mask:0xf bank_mask:0xf bound_ctrl:0
    s_nop 0
    v_add_f32_dpp v68, v68, v68 row_shr:2 row_mask:0xf bank_mask:0xf bound_ctrl:0
    v_add_f32_dpp v76, v76, v76 row_shr:2 row_mask:0xf bank_mask:0xf bound_ctrl:0
    s_nop 0
    v_add_f32_dpp v68, v68, v68 row_shr:4 row_mask:0xf bank_mask:0xf bound_ctrl:0
    v_add_f32_dpp v76, v76, v76 row_shr:4 row_mask:0xf bank_mask:0xf bound_ctrl:0
    s_nop 0
    v_add_f32_dpp v68, v68, v68 row_shr:8 row_mask:0xf bank_mask:0xf bound_ctrl:0
    v_add_f32_dpp v76, v76, v76 row_shr:8 row_mask:0xf bank_mask:0xf bound_ctrl:0
    s_nop 0
    v_add_f32_dpp v68, v68, v68 row_bcast:15 row_mask:0xa bank_mask:0xf
    v_add_f32_dpp v76, v76, v76 row_bcast:15 row_mask:0xa bank_mask:0xf
    s_nop 0
    v_add_f32_dpp v68, v68, v68 row_bcast:31 row_mask:0xc bank_mask:0xf
    v_add_f32_dpp v76, v76, v76 row_bcast:31 row_mask:0xc bank_mask:0xf
    v_cvt_pk_bf16_f32 v68, v68, v76
    v_and_b32 v76, 0xffff0000, v68
    v_lshlrev_b32 v68, 16, v68
    v_mul_f32 v68, 0xbfb8aa3b, v68
    v_mul_f32 v76, 0xbfb8aa3b, v76
    v_exp_f32 v68, v68
    v_exp_f32 v76, v76
    s_nop 0
    v_add_f32 v68, 1.0, v68
    v_add_f32 v76, 1.0, v76
    v_rcp_f32 v68, v68
    v_rcp_f32 v76, v76
    s_nop 0
    v_cvt_pk_bf16_f32 v68, v68, v76
    v_and_b32 v18, 0xffff0000, v68
    v_lshlrev_b32 v16, 16, v68
    s_lshl_b32 s3, s60, 3
    s_add_u32 s3, s3, 6291456
    v_mov_b32 v62, s3
    v_mov_b32 v17, s27
    v_mov_b32 v19, s27
    s_mov_b32 exec_lo, 0
    s_mov_b32 exec_hi, 0x80000000
    global_store_dwordx2 v62, v[16:17], s[34:35] sc1
    global_store_dwordx2 v62, v[18:19], s[34:35] offset:8 sc1
    s_mov_b64 exec, -1
    v_mov_b32 v72, 0
    v_mov_b32 v73, 0
    v_mov_b32 v74, 0
    v_mov_b32 v75, 0
    v_add_u32 v67, s21, v53
    s_mov_b32 exec_hi, 0
    ds_write_b128 v67, v[72:75] offset:4096
    s_mov_b64 exec, -1
    s_mul_i32 s25, s20, 16640
    v_and_b32 v31, 15, v2
    v_lshrrev_b32 v32, 4, v2
    v_add_u32 v33, 1, v31
    v_and_b32 v34, 3, v33
    v_lshrrev_b32 v33, 2, v33
    v_mul_u32_u24 v34, 4160, v34
    v_lshlrev_b32 v33, 3, v33
    v_lshlrev_b32 v35, 4, v32
    v_add3_u32 v34, v34, v33, v35
    v_add_u32 v4, s25, v34
    v_sub_u32 v33, 15, v31
    v_lshlrev_b32 v33, 5, v33
    v_add3_u32 v5, v33, v35, s21
    v_lshlrev_b32 v33, 1, v32
    v_xor_b32 v33, v31, v33
    v_lshlrev_b32 v33, 4, v33
    v_lshl_add_u32 v33, v32, 8, v33
    s_lshl_b32 s3, s20, 10
    s_add_u32 s3, s3, 84992
    v_add_u32 v6, s3, v33
    s_lshl_b32 s3, s20, 8
    s_add_u32 s3, s3, 117760
    v_lshlrev_b32 v3, 2, v2
    v_add_u32 v3, s3, v3
    v_add_u32 v1, s24, v53
    v_mov_b32 v7, v53
    v_mov_b32 v0, 1
    s_waitcnt lgkmcnt(0)
L_mid_done:
    v_mov_b32 v136, 139264
    s_barrier
    s_cmp_ge_u32 s14, 4
    s_cbranch_scc1 L_helper_go
    ds_read_b64 v[40:41], v4 offset:0
    ds_read_b64 v[42:43], v4 offset:8
    ds_read_b64 v[44:45], v4 offset:64
    ds_read_b64 v[46:47], v4 offset:72
    ds_read_b64 v[48:49], v4 offset:128
    ds_read_b64 v[50:51], v4 offset:136
    ds_read_b64 v[52:53], v4 offset:192
    ds_read_b64 v[54:55], v4 offset:200
    ds_read_b64 v[56:57], v4 offset:256
    ds_read_b64 v[58:59], v4 offset:264
    ds_read_b64 v[60:61], v4 offset:320
    ds_read_b64 v[62:63], v4 offset:328
    ds_read_b64 v[64:65], v4 offset:384
    ds_read_b64 v[66:67], v4 offset:392
    ds_read_b64 v[68:69], v4 offset:448
    ds_read_b64 v[70:71], v4 offset:456
    ds_read_b64 v[72:73], v4 offset:512
    ds_read_b64 v[74:75], v4 offset:520
    ds_read_b64 v[76:77], v4 offset:576
    ds_read_b64 v[78:79], v4 offset:584
    ds_read_b64 v[80:81], v4 offset:640
    ds_read_b64 v[82:83], v4 offset:648
    ds_read_b64 v[84:85], v4 offset:704
    ds_read_b64 v[86:87], v4 offset:712
    ds_read_b64 v[88:89], v4 offset:768
    ds_read_b64 v[90:91], v4 offset:776
    ds_read_b64 v[92:93], v4 offset:832
    ds_read_b64 v[94:95], v4 offset:840
    ds_read_b64 v[96:97], v4 offset:896
    ds_read_b64 v[98:99], v4 offset:904
    ds_read_b64 v[100:101], v4 offset:960
    ds_read_b64 v[102:103], v4 offset:968
    ds_read_b64 v[104:105], v4 offset:1024
    ds_read_b64 v[106:107], v4 offset:1032
    ds_read_b64 v[108:109], v4 offset:1088
    ds_read_b64 v[110:111], v4 offset:1096
    ds_read_b64 v[112:113], v4 offset:1152
    ds_read_b64 v[114:115], v4 offset:1160
    ds_read_b64 v[116:117], v4 offset:1216
    ds_read_b64 v[118:119], v4 offset:1224
    ds_read_b64 v[120:121], v4 offset:1280
    ds_read_b64 v[122:123], v4 offset:1288
    ds_read_b64 v[124:125], v4 offset:1344
    ds_read_b64 v[126:127], v4 offset:1352
    ds_read_b64 v[128:129], v4 offset:1408
    ds_read_b64 v[130:131], v4 offset:1416
    ds_read_b64 v[132:133], v4 offset:1472
    ds_read_b64 v[134:135], v4 offset:1480
    ds_read_b64 v[136:137], v4 offset:1536
    ds_read_b64 v[138:139], v4 offset:1544
    ds_read_b64 v[140:141], v4 offset:1600
    ds_read_b64 v[142:143], v4 offset:1608
    ds_read_b64 v[144:145], v4 offset:1664
    ds_read_b64 v[146:147], v4 offset:1672
    ds_read_b64 v[148:149], v4 offset:1728
    ds_read_b64 v[150:151], v4 offset:1736
    ds_read_b64 v[152:153], v4 offset:1792
    ds_read_b64 v[154:155], v4 offset:1800
    ds_read_b64 v[156:157], v4 offset:1856
    ds_read_b64 v[158:159], v4 offset:1864
    ds_read_b64 v[160:161], v4 offset:1920
    ds_read_b64 v[162:163], v4 offset:1928
    ds_read_b64 v[164:165], v4 offset:1984
    ds_read_b64 v[166:167], v4 offset:1992
    s_barrier
    global_load_dwordx4 v[8:11], v7, s[22:23] sc1
    global_load_dwordx4 v[12:15], v7, s[22:23] offset:1024 sc1
    s_waitcnt vmcnt(1)
    ds_write_b128 v1, v[8:11]
    s_waitcnt vmcnt(0)
    ds_write_b128 v1, v[12:15] offset:1024
    s_waitcnt lgkmcnt(0)
    s_barrier
    ds_read_b128 v[168:171], v5 offset:3584
    ds_read_b128 v[172:175], v5 offset:3648
    ds_read_b128 v[176:179], v5 offset:3712
    ds_read_b128 v[180:183], v5 offset:3776
    ds_read_b128 v[184:187], v5 offset:3840
    ds_read_b128 v[188:191], v5 offset:3904
    ds_read_b128 v[192:195], v5 offset:3968
    ds_read_b128 v[196:199], v5 offset:4032
    ds_read_b128 v[200:203], v5 offset:3072
    ds_read_b128 v[204:207], v5 offset:3136
    s_waitcnt lgkmcnt(9)
    v_mfma_f32_16x16x32_bf16 v[8:11], v[40:43], v[168:171], 0
    v_mfma_f32_16x16x32_bf16 v[12:15], v[72:75], v[168:171], 0
    ds_read_b128 v[208:211], v5 offset:3200
    v_mfma_f32_16x16x32_bf16 v[16:19], v[104:107], v[168:171], 0
    ds_read_b128 v[212:215], v5 offset:3264
    v_mfma_f32_16x16x32_bf16 v[20:23], v[136:139], v[168:171], 0
    ds_read_b128 v[216:219], v5 offset:3328
    s_waitcnt lgkmcnt(11)
    v_mfma_f32_16x16x32_bf16 v[8:11], v[44:47], v[172:175], v[8:11]
    ds_read_b128 v[220:223], v5 offset:3392
    v_mfma_f32_16x16x32_bf16 v[12:15], v[76:79], v[172:175], v[12:15]
    ds_read_b128 v[224:227], v5 offset:3456
    v_mfma_f32_16x16x32_bf16 v[16:19], v[108:111], v[172:175], v[16:19]
    ds_read_b128 v[228:231], v5 offset:3520
    v_mfma_f32_16x16x32_bf16 v[20:23], v[140:143], v[172:175], v[20:23]
    ds_read_b128 v[232:235], v5 offset:2560
    s_waitcnt lgkmcnt(14)
    v_mfma_f32_16x16x32_bf16 v[8:11], v[48:51], v[176:179], v[8:11]
    v_mfma_f32_16x16x32_bf16 v[12:15], v[80:83], v[176:179], v[12:15]
    ds_read_b128 v[236:239], v5 offset:2624
    v_mfma_f32_16x16x32_bf16 v[16:19], v[112:115], v[176:179], v[16:19]
    ds_read_b128 v[240:243], v5 offset:2688
    v_mfma_f32_16x16x32_bf16 v[20:23], v[144:147], v[176:179], v[20:23]
    ds_read_b128 v[244:247], v5 offset:2752
    s_waitcnt lgkmcnt(10)
    v_mfma_f32_16x16x32_bf16 v[8:11], v[52:55], v[180:183], v[8:11]
    ds_read_b128 v[248:251], v5 offset:2816
    v_mfma_f32_16x16x32_bf16 v[12:15], v[84:87], v[180:183], v[12:15]
    ds_read_b128 v[252:255], v5 offset:2880
    v_mfma_f32_16x16x32_bf16 v[16:19], v[116:119], v[180:183], v[16:19]
    v_mfma_f32_16x16x32_bf16 v[20:23], v[148:151], v[180:183], v[20:23]
    v_mfma_f32_16x16x32_bf16 v[8:11], v[56:59], v[184:187], v[8:11]
    v_mfma_f32_16x16x32_bf16 v[12:15], v[88:91], v[184:187], v[12:15]
    v_mfma_f32_16x16x32_bf16 v[16:19], v[120:123], v[184:187], v[16:19]
    v_mfma_f32_16x16x32_bf16 v[20:23], v[152:155], v[184:187], v[20:23]
    v_mfma_f32_16x16x32_bf16 v[8:11], v[60:63], v[188:191], v[8:11]
    v_mfma_f32_16x16x32_bf16 v[12:15], v[92:95], v[188:191], v[12:15]
    v_mfma_f32_16x16x32_bf16 v[16:19], v[124:127], v[188:191], v[16:19]
    v_mfma_f32_16x16x32_bf16 v[20:23], v[156:159], v[188:191], v[20:23]
    v_mfma_f32_16x16x32_bf16 v[8:11], v[64:67], v[192:195], v[8:11]
    v_mfma_f32_16x16x32_bf16 v[12:15], v[96:99], v[192:195], v[12:15]
    v_mfma_f32_16x16x32_bf16 v[16:19], v[128:131], v[192:195], v[16:19]
    v_mfma_f32_16x16x32_bf16 v[20:23], v[160:163], v[192:195], v[20:23]
    v_mfma_f32_16x16x32_bf16 v[8:11], v[68:71], v[196:199], v[8:11]
    v_mfma_f32_16x16x32_bf16 v[12:15], v[100:103], v[196:199], v[12:15]
    v_mfma_f32_16x16x32_bf16 v[16:19], v[132:135], v[196:199], v[16:19]
    v_mfma_f32_16x16x32_bf16 v[20:23], v[164:167], v[196:199], v[20:23]
    v_mfma_f32_16x16x32_bf16 v[12:15], v[40:43], v[200:203], v[12:15]
    v_mfma_f32_16x16x32_bf16 v[16:19], v[72:75], v[200:203], v[16:19]
    v_mfma_f32_16x16x32_bf16 v[20:23], v[104:107], v[200:203], v[20:23]
    v_mfma_f32_16x16x32_bf16 v[12:15], v[44:47], v[204:207], v[12:15]
    v_mfma_f32_16x16x32_bf16 v[16:19], v[76:79], v[204:207], v[16:19]
    ds_write_b128 v6, v[8:11] offset:0
    ds_write_b32 v3, v0 offset:0
    v_mfma_f32_16x16x32_bf16 v[20:23], v[108:111], v[204:207], v[20:23]
    s_waitcnt lgkmcnt(2)
    v_mfma_f32_16x16x32_bf16 v[12:15], v[48:51], v[208:211], v[12:15]
    v_mfma_f32_16x16x32_bf16 v[16:19], v[80:83], v[208:211], v[16:19]
    v_mfma_f32_16x16x32_bf16 v[20:23], v[112:115], v[208:211], v[20:23]
    v_mfma_f32_16x16x32_bf16 v[12:15], v[52:55], v[212:215], v[12:15]
    v_mfma_f32_16x16x32_bf16 v[16:19], v[84:87], v[212:215], v[16:19]
    v_mfma_f32_16x16x32_bf16 v[20:23], v[116:119], v[212:215], v[20:23]
    v_mfma_f32_16x16x32_bf16 v[12:15], v[56:59], v[216:219], v[12:15]
    v_mfma_f32_16x16x32_bf16 v[16:19], v[88:91], v[216:219], v[16:19]
    v_mfma_f32_16x16x32_bf16 v[20:23], v[120:123], v[216:219], v[20:23]
    v_mfma_f32_16x16x32_bf16 v[12:15], v[60:63], v[220:223], v[12:15]
    v_mfma_f32_16x16x32_bf16 v[16:19], v[92:95], v[220:223], v[16:19]
    v_mfma_f32_16x16x32_bf16 v[20:23], v[124:127], v[220:223], v[20:23]
    v_mfma_f32_16x16x32_bf16 v[12:15], v[64:67], v[224:227], v[12:15]
    v_mfma_f32_16x16x32_bf16 v[16:19], v[96:99], v[224:227], v[16:19]
    v_mfma_f32_16x16x32_bf16 v[20:23], v[128:131], v[224:227], v[20:23]
    v_mfma_f32_16x16x32_bf16 v[12:15], v[68:71], v[228:231], v[12:15]
    v_mfma_f32_16x16x32_bf16 v[16:19], v[100:103], v[228:231], v[16:19]
    v_mfma_f32_16x16x32_bf16 v[20:23], v[132:135], v[228:231], v[20:23]
    v_mfma_f32_16x16x32_bf16 v[16:19], v[40:43], v[232:235], v[16:19]
    v_mfma_f32_16x16x32_bf16 v[20:23], v[72:75], v[232:235], v[20:23]
    ds_read_b128 v[196:199], v5 offset:2944
    v_mfma_f32_16x16x32_bf16 v[16:19], v[44:47], v[236:239], v[16:19]
    v_mfma_f32_16x16x32_bf16 v[20:23], v[76:79], v[236:239], v[20:23]
    ds_read_b128 v[192:195], v5 offset:3008
    v_mfma_f32_16x16x32_bf16 v[16:19], v[48:51], v[240:243], v[16:19]
    ds_write_b128 v6, v[12:15] offset:4096
    ds_write_b32 v3, v0 offset:1024
    v_mfma_f32_16x16x32_bf16 v[20:23], v[80:83], v[240:243], v[20:23]
    ds_read_b128 v[188:191], v5 offset:2048
    v_mfma_f32_16x16x32_bf16 v[16:19], v[52:55], v[244:247], v[16:19]
    ds_read_b128 v[184:187], v5 offset:2112
    v_mfma_f32_16x16x32_bf16 v[20:23], v[84:87], v[244:247], v[20:23]
    ds_read_b128 v[180:183], v5 offset:2176
    v_mfma_f32_16x16x32_bf16 v[16:19], v[56:59], v[248:251], v[16:19]
    ds_read_b128 v[176:179], v5 offset:2240
    v_mfma_f32_16x16x32_bf16 v[20:23], v[88:91], v[248:251], v[20:23]
    ds_read_b128 v[172:175], v5 offset:2304
    v_mfma_f32_16x16x32_bf16 v[16:19], v[60:63], v[252:255], v[16:19]
    ds_read_b128 v[168:171], v5 offset:2368
    v_mfma_f32_16x16x32_bf16 v[20:23], v[92:95], v[252:255], v[20:23]
    ds_read_b128 v[228:231], v5 offset:2432
    s_waitcnt lgkmcnt(10)
    v_mfma_f32_16x16x32_bf16 v[16:19], v[64:67], v[196:199], v[16:19]
    ds_read_b128 v[224:227], v5 offset:2496
    v_mfma_f32_16x16x32_bf16 v[20:23], v[96:99], v[196:199], v[20:23]
    ds_read_b128 v[220:223], v5 offset:0
    s_waitcnt lgkmcnt(11)
    v_mfma_f32_16x16x32_bf16 v[16:19], v[68:71], v[192:195], v[16:19]
    ds_read_b128 v[216:219], v5 offset:1024
    v_mfma_f32_16x16x32_bf16 v[20:23], v[100:103], v[192:195], v[20:23]
    s_waitcnt lgkmcnt(9)
    v_mfma_f32_16x16x32_bf16 v[20:23], v[40:43], v[188:191], v[20:23]
    s_waitcnt lgkmcnt(8)
    v_mfma_f32_16x16x32_bf16 v[20:23], v[44:47], v[184:187], v[20:23]
    ds_read_b128 v[212:215], v5 offset:64
    s_waitcnt lgkmcnt(8)
    v_mfma_f32_16x16x32_bf16 v[20:23], v[48:51], v[180:183], v[20:23]
    ds_write_b128 v6, v[16:19] offset:8192
    ds_write_b32 v3, v0 offset:2048
    s_waitcnt lgkmcnt(9)
    v_mfma_f32_16x16x32_bf16 v[20:23], v[52:55], v[176:179], v[20:23]
    ds_read_b128 v[176:179], v5 offset:1088
    s_waitcnt lgkmcnt(9)
    v_mfma_f32_16x16x32_bf16 v[20:23], v[56:59], v[172:175], v[20:23]
    s_waitcnt lgkmcnt(8)
    v_mfma_f32_16x16x32_bf16 v[20:23], v[60:63], v[168:171], v[20:23]
    ds_read_b128 v[168:171], v5 offset:128
    s_waitcnt lgkmcnt(8)
    v_mfma_f32_16x16x32_bf16 v[20:23], v[64:67], v[228:231], v[20:23]
    ds_read_b128 v[228:231], v5 offset:1152
    s_waitcnt lgkmcnt(8)
    v_mfma_f32_16x16x32_bf16 v[20:23], v[68:71], v[224:227], v[20:23]
    s_waitcnt lgkmcnt(7)
    v_mfma_f32_16x16x32_bf16 v[36:39], v[40:43], v[220:223], 0
    ds_read_b128 v[220:223], v5 offset:192
    s_waitcnt lgkmcnt(7)
    v_mfma_f32_16x16x32_bf16 v[28:31], v[40:43], v[216:219], 0
    v_mfma_f32_16x16x32_bf16 v[32:35], v[72:75], v[216:219], 0
    ds_read_b128 v[224:227], v5 offset:1216
    v_mfma_f32_16x16x32_bf16 v[36:39], v[104:107], v[216:219], v[36:39]
    ds_write_b128 v6, v[20:23] offset:12288
    ds_write_b32 v3, v0 offset:3072
    s_waitcnt lgkmcnt(9)
    v_mfma_f32_16x16x32_bf16 v[36:39], v[44:47], v[212:215], v[36:39]
    s_waitcnt lgkmcnt(6)
    v_mfma_f32_16x16x32_bf16 v[28:31], v[44:47], v[176:179], v[28:31]
    ds_read_b128 v[212:215], v5 offset:256
    v_mfma_f32_16x16x32_bf16 v[32:35], v[76:79], v[176:179], v[32:35]
    ds_read_b128 v[216:219], v5 offset:1280
    v_mfma_f32_16x16x32_bf16 v[36:39], v[108:111], v[176:179], v[36:39]
    ds_read_b128 v[176:179], v5 offset:320
    s_waitcnt lgkmcnt(8)
    v_mfma_f32_16x16x32_bf16 v[36:39], v[48:51], v[168:171], v[36:39]
    s_waitcnt lgkmcnt(7)
    v_mfma_f32_16x16x32_bf16 v[28:31], v[48:51], v[228:231], v[28:31]
    ds_read_b128 v[168:171], v5 offset:1344
    v_mfma_f32_16x16x32_bf16 v[32:35], v[80:83], v[228:231], v[32:35]
    v_mfma_f32_16x16x32_bf16 v[36:39], v[112:115], v[228:231], v[36:39]
    ds_read_b128 v[228:231], v5 offset:384
    s_waitcnt lgkmcnt(8)
    v_mfma_f32_16x16x32_bf16 v[36:39], v[52:55], v[220:223], v[36:39]
    ds_read_b128 v[220:223], v5 offset:1408
    s_waitcnt lgkmcnt(8)
    v_mfma_f32_16x16x32_bf16 v[28:31], v[52:55], v[224:227], v[28:31]
    v_mfma_f32_16x16x32_bf16 v[32:35], v[84:87], v[224:227], v[32:35]
    v_mfma_f32_16x16x32_bf16 v[36:39], v[116:119], v[224:227], v[36:39]
    ds_read_b128 v[224:227], v5 offset:448
    s_waitcnt lgkmcnt(6)
    v_mfma_f32_16x16x32_bf16 v[36:39], v[56:59], v[212:215], v[36:39]
    ds_read_b128 v[212:215], v5 offset:1472
    s_waitcnt lgkmcnt(6)
    v_mfma_f32_16x16x32_bf16 v[28:31], v[56:59], v[216:219], v[28:31]
    v_mfma_f32_16x16x32_bf16 v[32:35], v[88:91], v[216:219], v[32:35]
    v_mfma_f32_16x16x32_bf16 v[36:39], v[120:123], v[216:219], v[36:39]
    ds_read_b128 v[216:219], v5 offset:512
    s_waitcnt lgkmcnt(6)
    v_mfma_f32_16x16x32_bf16 v[36:39], v[60:63], v[176:179], v[36:39]
    ds_read_b128 v[176:179], v5 offset:576
    s_waitcnt lgkmcnt(6)
    v_mfma_f32_16x16x32_bf16 v[28:31], v[60:63], v[168:171], v[28:31]
    v_mfma_f32_16x16x32_bf16 v[32:35], v[92:95], v[168:171], v[32:35]
    v_mfma_f32_16x16x32_bf16 v[36:39], v[124:127], v[168:171], v[36:39]
    ds_read_b128 v[168:171], v5 offset:640
    s_waitcnt lgkmcnt(6)
    v_mfma_f32_16x16x32_bf16 v[36:39], v[64:67], v[228:231], v[36:39]
    ds_read_b128 v[228:231], v5 offset:704
    s_waitcnt lgkmcnt(6)
    v_mfma_f32_16x16x32_bf16 v[28:31], v[64:67], v[220:223], v[28:31]
    v_mfma_f32_16x16x32_bf16 v[32:35], v[96:99], v[220:223], v[32:35]
    v_mfma_f32_16x16x32_bf16 v[36:39], v[128:131], v[220:223], v[36:39]
    ds_read_b128 v[220:223], v5 offset:768
    s_waitcnt lgkmcnt(6)
    v_mfma_f32_16x16x32_bf16 v[36:39], v[68:71], v[224:227], v[36:39]
    ds_read_b128 v[224:227], v5 offset:832
    s_waitcnt lgkmcnt(6)
    v_mfma_f32_16x16x32_bf16 v[28:31], v[68:71], v[212:215], v[28:31]
    v_mfma_f32_16x16x32_bf16 v[32:35], v[100:103], v[212:215], v[32:35]
    v_mfma_f32_16x16x32_bf16 v[36:39], v[132:135], v[212:215], v[36:39]
    ds_read_b128 v[212:215], v5 offset:896
    s_waitcnt lgkmcnt(6)
    v_mfma_f32_16x16x32_bf16 v[32:35], v[40:43], v[216:219], v[32:35]
    v_mfma_f32_16x16x32_bf16 v[36:39], v[72:75], v[216:219], v[36:39]
    ds_read_b128 v[216:219], v5 offset:960
    v_mfma_f32_16x16x32_bf16 v[24:27], v[104:107], v[232:235], 0
    v_mfma_f32_16x16x32_bf16 v[28:31], v[136:139], v[232:235], v[28:31]
    s_waitcnt lgkmcnt(5)
    v_mfma_f32_16x16x32_bf16 v[32:35], v[44:47], v[176:179], v[32:35]
    v_mfma_f32_16x16x32_bf16 v[36:39], v[76:79], v[176:179], v[36:39]
    ds_read_b128 v[176:179], v5 offset:1536
    v_mfma_f32_16x16x32_bf16 v[24:27], v[108:111], v[236:239], v[24:27]
    v_mfma_f32_16x16x32_bf16 v[28:31], v[140:143], v[236:239], v[28:31]
    v_mfma_f32_16x16x32_bf16 v[32:35], v[48:51], v[168:171], v[32:35]
    v_mfma_f32_16x16x32_bf16 v[36:39], v[80:83], v[168:171], v[36:39]
    ds_read_b128 v[168:171], v5 offset:1600
    v_mfma_f32_16x16x32_bf16 v[24:27], v[112:115], v[240:243], v[24:27]
    v_mfma_f32_16x16x32_bf16 v[28:31], v[144:147], v[240:243], v[28:31]
    s_waitcnt lgkmcnt(3)
    v_mfma_f32_16x16x32_bf16 v[32:35], v[52:55], v[228:231], v[32:35]
    v_mfma_f32_16x16x32_bf16 v[36:39], v[84:87], v[228:231], v[36:39]
    ds_read_b128 v[228:231], v5 offset:1664
    v_mfma_f32_16x16x32_bf16 v[24:27], v[116:119], v[244:247], v[24:27]
    v_mfma_f32_16x16x32_bf16 v[28:31], v[148:151], v[244:247], v[28:31]
    v_mfma_f32_16x16x32_bf16 v[32:35], v[56:59], v[220:223], v[32:35]
    v_mfma_f32_16x16x32_bf16 v[36:39], v[88:91], v[220:223], v[36:39]
    ds_read_b128 v[220:223], v5 offset:1728
    v_mfma_f32_16x16x32_bf16 v[24:27], v[120:123], v[248:251], v[24:27]
    v_mfma_f32_16x16x32_bf16 v[28:31], v[152:155], v[248:251], v[28:31]
    v_mfma_f32_16x16x32_bf16 v[32:35], v[60:63], v[224:227], v[32:35]
    v_mfma_f32_16x16x32_bf16 v[36:39], v[92:95], v[224:227], v[36:39]
    ds_read_b128 v[224:227], v5 offset:1792
    v_mfma_f32_16x16x32_bf16 v[24:27], v[124:127], v[252:255], v[24:27]
    v_mfma_f32_16x16x32_bf16 v[28:31], v[156:159], v[252:255], v[28:31]
    v_mfma_f32_16x16x32_bf16 v[32:35], v[64:67], v[212:215], v[32:35]
    v_mfma_f32_16x16x32_bf16 v[36:39], v[96:99], v[212:215], v[36:39]
    ds_read_b128 v[212:215], v5 offset:1856
    v_mfma_f32_16x16x32_bf16 v[24:27], v[128:131], v[196:199], v[24:27]
    v_mfma_f32_16x16x32_bf16 v[28:31], v[160:163], v[196:199], v[28:31]
    s_waitcnt lgkmcnt(3)
    v_mfma_f32_16x16x32_bf16 v[32:35], v[68:71], v[216:219], v[32:35]
    v_mfma_f32_16x16x32_bf16 v[36:39], v[100:103], v[216:219], v[36:39]
    ds_read_b128 v[216:219], v5 offset:1920
    v_mfma_f32_16x16x32_bf16 v[24:27], v[132:135], v[192:195], v[24:27]
    v_mfma_f32_16x16x32_bf16 v[28:31], v[164:167], v[192:195], v[28:31]
    v_mfma_f32_16x16x32_bf16 v[24:27], v[40:43], v[176:179], v[24:27]
    ds_read_b128 v[40:43], v5 offset:1984
    v_mfma_f32_16x16x32_bf16 v[28:31], v[72:75], v[176:179], v[28:31]
    v_mfma_f32_16x16x32_bf16 v[32:35], v[104:107], v[176:179], v[32:35]
    v_mfma_f32_16x16x32_bf16 v[36:39], v[136:139], v[176:179], v[36:39]
    ds_read_b128 v[176:179], v5 offset:2240
    v_mfma_f32_16x16x32_bf16 v[24:27], v[44:47], v[168:171], v[24:27]
    ds_read_b128 v[44:47], v5 offset:3264
    v_mfma_f32_16x16x32_bf16 v[28:31], v[76:79], v[168:171], v[28:31]
    v_mfma_f32_16x16x32_bf16 v[32:35], v[108:111], v[168:171], v[32:35]
    v_mfma_f32_16x16x32_bf16 v[36:39], v[140:143], v[168:171], v[36:39]
    ds_read_b128 v[168:171], v5 offset:3328
    v_mfma_f32_16x16x32_bf16 v[24:27], v[48:51], v[228:231], v[24:27]
    ds_read_b128 v[48:51], v5 offset:2368
    v_mfma_f32_16x16x32_bf16 v[28:31], v[80:83], v[228:231], v[28:31]
    v_mfma_f32_16x16x32_bf16 v[32:35], v[112:115], v[228:231], v[32:35]
    v_mfma_f32_16x16x32_bf16 v[36:39], v[144:147], v[228:231], v[36:39]
    ds_read_b128 v[228:231], v5 offset:3392
    s_waitcnt lgkmcnt(6)
    v_mfma_f32_16x16x32_bf16 v[24:27], v[52:55], v[220:223], v[24:27]
    ds_read_b128 v[52:55], v5 offset:2432
    v_mfma_f32_16x16x32_bf16 v[28:31], v[84:87], v[220:223], v[28:31]
    v_mfma_f32_16x16x32_bf16 v[32:35], v[116:119], v[220:223], v[32:35]
    v_mfma_f32_16x16x32_bf16 v[36:39], v[148:151], v[220:223], v[36:39]
    ds_read_b128 v[220:223], v5 offset:3456
    v_mfma_f32_16x16x32_bf16 v[24:27], v[56:59], v[224:227], v[24:27]
    ds_read_b128 v[56:59], v5 offset:2496
    v_mfma_f32_16x16x32_bf16 v[28:31], v[88:91], v[224:227], v[28:31]
    v_mfma_f32_16x16x32_bf16 v[32:35], v[120:123], v[224:227], v[32:35]
    v_mfma_f32_16x16x32_bf16 v[36:39], v[152:155], v[224:227], v[36:39]
    ds_read_b128 v[224:227], v5 offset:3520
    v_mfma_f32_16x16x32_bf16 v[24:27], v[60:63], v[212:215], v[24:27]
    ds_read_b64 v[60:61], v4 offset:2048
    ds_read_b64 v[62:63], v4 offset:2056
    v_mfma_f32_16x16x32_bf16 v[28:31], v[92:95], v[212:215], v[28:31]
    v_mfma_f32_16x16x32_bf16 v[32:35], v[124:127], v[212:215], v[32:35]
    v_mfma_f32_16x16x32_bf16 v[36:39], v[156:159], v[212:215], v[36:39]
    ds_read_b128 v[212:215], v5 offset:3584
    v_mfma_f32_16x16x32_bf16 v[24:27], v[64:67], v[216:219], v[24:27]
    ds_read_b64 v[64:65], v4 offset:2560
    ds_read_b64 v[66:67], v4 offset:2568
    v_mfma_f32_16x16x32_bf16 v[28:31], v[96:99], v[216:219], v[28:31]
    v_mfma_f32_16x16x32_bf16 v[32:35], v[128:131], v[216:219], v[32:35]
    v_mfma_f32_16x16x32_bf16 v[36:39], v[160:163], v[216:219], v[36:39]
    ds_read_b64 v[216:217], v4 offset:3072
    ds_read_b64 v[218:219], v4 offset:3080
    s_waitcnt lgkmcnt(9)
    v_mfma_f32_16x16x32_bf16 v[24:27], v[68:71], v[40:43], v[24:27]
    ds_read_b64 v[68:69], v4 offset:3584
    ds_read_b64 v[70:71], v4 offset:3592
    v_mfma_f32_16x16x32_bf16 v[28:31], v[100:103], v[40:43], v[28:31]
    v_mfma_f32_16x16x32_bf16 v[32:35], v[132:135], v[40:43], v[32:35]
    v_mfma_f32_16x16x32_bf16 v[36:39], v[164:167], v[40:43], v[36:39]
    ds_read_b64 v[40:41], v4 offset:2112
    ds_read_b64 v[42:43], v4 offset:2120
    v_mfma_f32_16x16x32_bf16 v[24:27], v[72:75], v[188:191], v[24:27]
    ds_read_b128 v[72:75], v5 offset:3648
    v_mfma_f32_16x16x32_bf16 v[28:31], v[104:107], v[188:191], v[28:31]
    ds_read_b64 v[104:105], v4 offset:2624
    ds_read_b64 v[106:107], v4 offset:2632
    v_mfma_f32_16x16x32_bf16 v[32:35], v[136:139], v[188:191], v[32:35]
    v_mfma_f32_16x16x32_bf16 v[24:27], v[136:139], v[200:203], v[24:27]
    ds_read_b64 v[136:137], v4 offset:3136
    ds_read_b64 v[138:139], v4 offset:3144
    v_mfma_f32_16x16x32_bf16 v[24:27], v[76:79], v[184:187], v[24:27]
    ds_read_b64 v[76:77], v4 offset:3648
    ds_read_b64 v[78:79], v4 offset:3656
    v_mfma_f32_16x16x32_bf16 v[28:31], v[108:111], v[184:187], v[28:31]
    ds_read_b64 v[108:109], v4 offset:2176
    ds_read_b64 v[110:111], v4 offset:2184
    v_mfma_f32_16x16x32_bf16 v[32:35], v[140:143], v[184:187], v[32:35]
    v_mfma_f32_16x16x32_bf16 v[24:27], v[140:143], v[204:207], v[24:27]
    ds_read_b128 v[140:143], v5 offset:3712
    v_mfma_f32_16x16x32_bf16 v[24:27], v[80:83], v[180:183], v[24:27]
    ds_read_b64 v[80:81], v4 offset:2688
    ds_read_b64 v[82:83], v4 offset:2696
    v_mfma_f32_16x16x32_bf16 v[28:31], v[112:115], v[180:183], v[28:31]
    ds_read_b64 v[112:113], v4 offset:3200
    ds_read_b64 v[114:115], v4 offset:3208
    v_mfma_f32_16x16x32_bf16 v[32:35], v[144:147], v[180:183], v[32:35]
    v_mfma_f32_16x16x32_bf16 v[24:27], v[144:147], v[208:211], v[24:27]
    ds_read_b64 v[144:145], v4 offset:3712
    ds_read_b64 v[146:147], v4 offset:3720
    v_mfma_f32_16x16x32_bf16 v[24:27], v[84:87], v[176:179], v[24:27]
    ds_read_b64 v[84:85], v4 offset:2240
    ds_read_b64 v[86:87], v4 offset:2248
    v_mfma_f32_16x16x32_bf16 v[28:31], v[116:119], v[176:179], v[28:31]
    ds_read_b128 v[116:119], v5 offset:3776
    v_mfma_f32_16x16x32_bf16 v[32:35], v[148:151], v[176:179], v[32:35]
    v_mfma_f32_16x16x32_bf16 v[24:27], v[148:151], v[44:47], v[24:27]
    ds_read_b64 v[148:149], v4 offset:2752
    ds_read_b64 v[150:151], v4 offset:2760
    v_mfma_f32_16x16x32_bf16 v[24:27], v[88:91], v[172:175], v[24:27]
    ds_read_b64 v[88:89], v4 offset:3264
    ds_read_b64 v[90:91], v4 offset:3272
    v_mfma_f32_16x16x32_bf16 v[28:31], v[120:123], v[172:175], v[28:31]
    ds_read_b64 v[120:121], v4 offset:3776
    ds_read_b64 v[122:123], v4 offset:3784
    v_mfma_f32_16x16x32_bf16 v[32:35], v[152:155], v[172:175], v[32:35]
    v_mfma_f32_16x16x32_bf16 v[24:27], v[152:155], v[168:171], v[24:27]
    ds_read_b64 v[152:153], v4 offset:2304
    ds_read_b64 v[154:155], v4 offset:2312
    v_mfma_f32_16x16x32_bf16 v[24:27], v[92:95], v[48:51], v[24:27]
    ds_read_b128 v[92:95], v5 offset:3840
    v_mfma_f32_16x16x32_bf16 v[28:31], v[124:127], v[48:51], v[28:31]
    ds_read_b64 v[124:125], v4 offset:2816
    ds_read_b64 v[126:127], v4 offset:2824
    v_mfma_f32_16x16x32_bf16 v[32:35], v[156:159], v[48:51], v[32:35]
    v_mfma_f32_16x16x32_bf16 v[24:27], v[156:159], v[228:231], v[24:27]
    ds_read_b64 v[156:157], v4 offset:3328
    ds_read_b64 v[158:159], v4 offset:3336
    v_mfma_f32_16x16x32_bf16 v[24:27], v[96:99], v[52:55], v[24:27]
    ds_read_b64 v[96:97], v4 offset:3840
    ds_read_b64 v[98:99], v4 offset:3848
    v_mfma_f32_16x16x32_bf16 v[28:31], v[128:131], v[52:55], v[28:31]
    ds_read_b64 v[128:129], v4 offset:2368
    ds_read_b64 v[130:131], v4 offset:2376
    v_mfma_f32_16x16x32_bf16 v[32:35], v[160:163], v[52:55], v[32:35]
    v_mfma_f32_16x16x32_bf16 v[24:27], v[160:163], v[220:223], v[24:27]
    ds_read_b128 v[160:163], v5 offset:3904
    s_waitcnt lgkmcnt(15)
    v_mfma_f32_16x16x32_bf16 v[24:27], v[100:103], v[56:59], v[24:27]
    ds_read_b64 v[100:101], v4 offset:2880
    ds_read_b64 v[102:103], v4 offset:2888
    v_mfma_f32_16x16x32_bf16 v[28:31], v[132:135], v[56:59], v[28:31]
    ds_read_b64 v[132:133], v4 offset:3392
    ds_read_b64 v[134:135], v4 offset:3400
    v_mfma_f32_16x16x32_bf16 v[32:35], v[164:167], v[56:59], v[32:35]
    v_mfma_f32_16x16x32_bf16 v[24:27], v[164:167], v[224:227], v[24:27]
    ds_read_b64 v[164:165], v4 offset:3904
    ds_read_b64 v[166:167], v4 offset:3912
    v_mfma_f32_16x16x32_bf16 v[24:27], v[60:63], v[212:215], v[24:27]
    v_mfma_f32_16x16x32_bf16 v[28:31], v[64:67], v[212:215], v[28:31]
    v_mfma_f32_16x16x32_bf16 v[32:35], v[216:219], v[212:215], v[32:35]
    v_mfma_f32_16x16x32_bf16 v[36:39], v[68:71], v[212:215], v[36:39]
    ds_read_b64 v[68:69], v4 offset:2432
    ds_read_b64 v[70:71], v4 offset:2440
    v_mfma_f32_16x16x32_bf16 v[24:27], v[40:43], v[72:75], v[24:27]
    ds_read_b128 v[212:215], v5 offset:3968
    v_mfma_f32_16x16x32_bf16 v[28:31], v[104:107], v[72:75], v[28:31]
    v_mfma_f32_16x16x32_bf16 v[32:35], v[136:139], v[72:75], v[32:35]
    v_mfma_f32_16x16x32_bf16 v[36:39], v[76:79], v[72:75], v[36:39]
    ds_read_b64 v[72:73], v4 offset:2944
    ds_read_b64 v[74:75], v4 offset:2952
    v_mfma_f32_16x16x32_bf16 v[24:27], v[108:111], v[140:143], v[24:27]
    ds_read_b64 v[76:77], v4 offset:3456
    ds_read_b64 v[78:79], v4 offset:3464
    v_mfma_f32_16x16x32_bf16 v[28:31], v[80:83], v[140:143], v[28:31]
    v_mfma_f32_16x16x32_bf16 v[32:35], v[112:115], v[140:143], v[32:35]
    v_mfma_f32_16x16x32_bf16 v[36:39], v[144:147], v[140:143], v[36:39]
    ds_read_b64 v[140:141], v4 offset:3968
    ds_read_b64 v[142:143], v4 offset:3976
    v_mfma_f32_16x16x32_bf16 v[24:27], v[84:87], v[116:119], v[24:27]
    ds_read_b64 v[144:145], v4 offset:2496
    ds_read_b64 v[146:147], v4 offset:2504
    v_mfma_f32_16x16x32_bf16 v[28:31], v[148:151], v[116:119], v[28:31]
    s_waitcnt lgkmcnt(11)
    v_mfma_f32_16x16x32_bf16 v[32:35], v[88:91], v[116:119], v[32:35]
    v_mfma_f32_16x16x32_bf16 v[36:39], v[120:123], v[116:119], v[36:39]
    ds_read_b128 v[116:119], v5 offset:4032
    v_mfma_f32_16x16x32_bf16 v[24:27], v[152:155], v[92:95], v[24:27]
    ds_read_b64 v[120:121], v4 offset:3008
    ds_read_b64 v[122:123], v4 offset:3016
    v_mfma_f32_16x16x32_bf16 v[28:31], v[124:127], v[92:95], v[28:31]
    v_mfma_f32_16x16x32_bf16 v[32:35], v[156:159], v[92:95], v[32:35]
    v_mfma_f32_16x16x32_bf16 v[36:39], v[96:99], v[92:95], v[36:39]
    ds_read_b64 v[92:93], v4 offset:3520
    ds_read_b64 v[94:95], v4 offset:3528
    v_mfma_f32_16x16x32_bf16 v[24:27], v[128:131], v[160:163], v[24:27]
    ds_read_b64 v[96:97], v4 offset:4032
    ds_read_b64 v[98:99], v4 offset:4040
    v_mfma_f32_16x16x32_bf16 v[28:31], v[100:103], v[160:163], v[28:31]
    v_mfma_f32_16x16x32_bf16 v[32:35], v[132:135], v[160:163], v[32:35]
    v_mfma_f32_16x16x32_bf16 v[36:39], v[164:167], v[160:163], v[36:39]
    s_waitcnt lgkmcnt(9)
    v_mfma_f32_16x16x32_bf16 v[24:27], v[68:71], v[212:215], v[24:27]
    v_mfma_f32_16x16x32_bf16 v[28:31], v[72:75], v[212:215], v[28:31]
    v_mfma_f32_16x16x32_bf16 v[32:35], v[76:79], v[212:215], v[32:35]
    v_mfma_f32_16x16x32_bf16 v[36:39], v[140:143], v[212:215], v[36:39]
    s_waitcnt lgkmcnt(6)
    v_mfma_f32_16x16x32_bf16 v[24:27], v[144:147], v[116:119], v[24:27]
    s_waitcnt lgkmcnt(4)
    v_mfma_f32_16x16x32_bf16 v[28:31], v[120:123], v[116:119], v[28:31]
    s_waitcnt lgkmcnt(2)
    v_mfma_f32_16x16x32_bf16 v[32:35], v[92:95], v[116:119], v[32:35]
    s_waitcnt lgkmcnt(0)
    v_mfma_f32_16x16x32_bf16 v[36:39], v[96:99], v[116:119], v[36:39]
    v_mfma_f32_16x16x32_bf16 v[28:31], v[60:63], v[200:203], v[28:31]
    v_mfma_f32_16x16x32_bf16 v[32:35], v[64:67], v[200:203], v[32:35]
    ds_write_b128 v6, v[24:27] offset:16384
    ds_write_b32 v3, v0 offset:4096
    v_mfma_f32_16x16x32_bf16 v[36:39], v[216:219], v[200:203], v[36:39]
    v_mfma_f32_16x16x32_bf16 v[28:31], v[40:43], v[204:207], v[28:31]
    v_mfma_f32_16x16x32_bf16 v[32:35], v[104:107], v[204:207], v[32:35]
    v_mfma_f32_16x16x32_bf16 v[36:39], v[136:139], v[204:207], v[36:39]
    v_mfma_f32_16x16x32_bf16 v[28:31], v[108:111], v[208:211], v[28:31]
    v_mfma_f32_16x16x32_bf16 v[32:35], v[80:83], v[208:211], v[32:35]
    v_mfma_f32_16x16x32_bf16 v[36:39], v[112:115], v[208:211], v[36:39]
    v_mfma_f32_16x16x32_bf16 v[28:31], v[84:87], v[44:47], v[28:31]
    v_mfma_f32_16x16x32_bf16 v[32:35], v[148:151], v[44:47], v[32:35]
    v_mfma_f32_16x16x32_bf16 v[36:39], v[88:91], v[44:47], v[36:39]
    v_mfma_f32_16x16x32_bf16 v[28:31], v[152:155], v[168:171], v[28:31]
    v_mfma_f32_16x16x32_bf16 v[32:35], v[124:127], v[168:171], v[32:35]
    v_mfma_f32_16x16x32_bf16 v[36:39], v[156:159], v[168:171], v[36:39]
    v_mfma_f32_16x16x32_bf16 v[28:31], v[128:131], v[228:231], v[28:31]
    v_mfma_f32_16x16x32_bf16 v[32:35], v[100:103], v[228:231], v[32:35]
    v_mfma_f32_16x16x32_bf16 v[36:39], v[132:135], v[228:231], v[36:39]
    v_mfma_f32_16x16x32_bf16 v[28:31], v[68:71], v[220:223], v[28:31]
    v_mfma_f32_16x16x32_bf16 v[32:35], v[72:75], v[220:223], v[32:35]
    v_mfma_f32_16x16x32_bf16 v[36:39], v[76:79], v[220:223], v[36:39]
    v_mfma_f32_16x16x32_bf16 v[28:31], v[144:147], v[224:227], v[28:31]
    v_mfma_f32_16x16x32_bf16 v[32:35], v[120:123], v[224:227], v[32:35]
    v_mfma_f32_16x16x32_bf16 v[36:39], v[92:95], v[224:227], v[36:39]
    v_mfma_f32_16x16x32_bf16 v[32:35], v[60:63], v[232:235], v[32:35]
    v_mfma_f32_16x16x32_bf16 v[36:39], v[64:67], v[232:235], v[36:39]
    v_mfma_f32_16x16x32_bf16 v[32:35], v[40:43], v[236:239], v[32:35]
    v_mfma_f32_16x16x32_bf16 v[36:39], v[104:107], v[236:239], v[36:39]
    v_mfma_f32_16x16x32_bf16 v[32:35], v[108:111], v[240:243], v[32:35]
    v_mfma_f32_16x16x32_bf16 v[36:39], v[80:83], v[240:243], v[36:39]
    ds_write_b128 v6, v[28:31] offset:20480
    ds_write_b32 v3, v0 offset:5120
    v_mfma_f32_16x16x32_bf16 v[32:35], v[84:87], v[244:247], v[32:35]
    v_mfma_f32_16x16x32_bf16 v[36:39], v[148:151], v[244:247], v[36:39]
    v_mfma_f32_16x16x32_bf16 v[32:35], v[152:155], v[248:251], v[32:35]
    v_mfma_f32_16x16x32_bf16 v[36:39], v[124:127], v[248:251], v[36:39]
    v_mfma_f32_16x16x32_bf16 v[32:35], v[128:131], v[252:255], v[32:35]
    v_mfma_f32_16x16x32_bf16 v[36:39], v[100:103], v[252:255], v[36:39]
    v_mfma_f32_16x16x32_bf16 v[32:35], v[68:71], v[196:199], v[32:35]
    v_mfma_f32_16x16x32_bf16 v[36:39], v[72:75], v[196:199], v[36:39]
    v_mfma_f32_16x16x32_bf16 v[32:35], v[144:147], v[192:195], v[32:35]
    v_mfma_f32_16x16x32_bf16 v[36:39], v[120:123], v[192:195], v[36:39]
    v_mfma_f32_16x16x32_bf16 v[36:39], v[60:63], v[188:191], v[36:39]
    v_mfma_f32_16x16x32_bf16 v[36:39], v[40:43], v[184:187], v[36:39]
    v_mfma_f32_16x16x32_bf16 v[36:39], v[108:111], v[180:183], v[36:39]
    v_mfma_f32_16x16x32_bf16 v[36:39], v[84:87], v[176:179], v[36:39]
    v_mfma_f32_16x16x32_bf16 v[36:39], v[152:155], v[172:175], v[36:39]
    v_mfma_f32_16x16x32_bf16 v[36:39], v[128:131], v[48:51], v[36:39]
    v_mfma_f32_16x16x32_bf16 v[36:39], v[68:71], v[52:55], v[36:39]
    ds_write_b128 v6, v[32:35] offset:24576
    ds_write_b32 v3, v0 offset:6144
    v_mfma_f32_16x16x32_bf16 v[36:39], v[144:147], v[56:59], v[36:39]
    s_nop 7
    ds_write_b128 v6, v[36:39] offset:28672
    ds_write_b32 v3, v0 offset:7168
    s_branch L_fin
L_helper_go:
    v_mov_b32 v20, 0
    v_mov_b32 v21, 0
    v_mov_b32 v22, 0
    v_mov_b32 v23, 0
    s_lshl_b32 s3, s68, 16
    v_mov_b32 v24, s3
    s_and_b32 s3, s68, 0xffff0000
    v_mov_b32 v25, s3
    s_lshl_b32 s3, s69, 16
    v_mov_b32 v26, s3
    s_and_b32 s3, s69, 0xffff0000
    v_mov_b32 v27, s3
    s_cmp_lg_u32 s14, 4
    s_cbranch_scc1 L_gload
    s_mov_b32 s28, 0
    s_mov_b32 exec_hi, 0
    global_load_dwordx4 v[104:107], v16, s[34:35] sc1
L_poll1:
    s_waitcnt vmcnt(1)
    v_xor_b32 v108, s27, v100
    v_xor_b32 v109, s27, v101
    v_xor_b32 v110, s27, v102
    v_xor_b32 v111, s27, v103
    v_or3_b32 v108, v108, v109, v110
    v_or_b32 v108, v108, v111
    v_cmp_ne_u32 vcc, 0, v108
    s_add_u32 s28, s28, 1
    s_cmp_gt_u32 s28, 0x100000
    s_cbranch_scc1 L_poll1_done
    s_cbranch_vccz L_poll1_done
    global_load_dwordx4 v[100:103], v16, s[34:35] sc1
    s_waitcnt vmcnt(1)
    v_xor_b32 v108, s27, v104
    v_xor_b32 v109, s27, v105
    v_xor_b32 v110, s27, v106
    v_xor_b32 v111, s27, v107
    v_or3_b32 v108, v108, v109, v110
    v_or_b32 v108, v108, v111
    v_cmp_ne_u32 vcc, 0, v108
    s_cbranch_vccz L_poll1_done
    global_load_dwordx4 v[104:107], v16, s[34:35] sc1
    s_branch L_poll1
L_poll1_done:
    s_mov_b64 exec, -1
L_gload:
    s_barrier
    global_load_dwordx4 v[40:43], v7, s[22:23] sc1
    global_load_dwordx4 v[44:47], v7, s[22:23] offset:1024 sc1
    v_add_u32 v16, 0, v13
    global_load_dwordx2 v[48:49], v16, s[34:35] sc1
    v_add_u32 v16, 2048, v13
    global_load_dwordx2 v[50:51], v16, s[34:35] sc1
    v_add_u32 v16, 4096, v13
    global_load_dwordx2 v[52:53], v16, s[34:35] sc1
    v_add_u32 v16, 6144, v13
    global_load_dwordx2 v[54:55], v16, s[34:35] sc1
    v_add_u32 v16, 8192, v13
    global_load_dwordx2 v[56:57], v16, s[34:35] sc1
    v_add_u32 v16, 10240, v13
    global_load_dwordx2 v[58:59], v16, s[34:35] sc1
    v_add_u32 v16, 12288, v13
    global_load_dwordx2 v[60:61], v16, s[34:35] sc1
    v_add_u32 v16, 14336, v13
    global_load_dwordx2 v[62:63], v16, s[34:35] sc1
    s_waitcnt vmcnt(9)
    ds_write_b128 v1, v[40:43]
    s_waitcnt vmcnt(8)
    ds_write_b128 v1, v[44:47] offset:1024
    s_waitcnt lgkmcnt(0)
    s_barrier
    s_waitcnt vmcnt(0)
    s_mov_b32 s28, 0
L_poll2:
    v_xor_b32 v17, s27, v49
    v_xor_b32 v16, s27, v51
    v_or_b32 v17, v17, v16
    v_xor_b32 v16, s27, v53
    v_or_b32 v17, v17, v16
    v_xor_b32 v16, s27, v55
    v_or_b32 v17, v17, v16
    v_xor_b32 v16, s27, v57
    v_or_b32 v17, v17, v16
    v_xor_b32 v16, s27, v59
    v_or_b32 v17, v17, v16
    v_xor_b32 v16, s27, v61
    v_or_b32 v17, v17, v16
    v_xor_b32 v16, s27, v63
    v_or_b32 v17, v17, v16
    v_cmp_ne_u32 vcc, 0, v17
    s_add_u32 s28, s28, 1
    s_cmp_gt_u32 s28, 0x100000
    s_cbranch_scc1 L_poll2_done
    s_cbranch_vccz L_poll2_done
    v_add_u32 v16, 0, v13
    global_load_dwordx2 v[48:49], v16, s[34:35] sc1
    v_add_u32 v16, 2048, v13
    global_load_dwordx2 v[50:51], v16, s[34:35] sc1
    v_add_u32 v16, 4096, v13
    global_load_dwordx2 v[52:53], v16, s[34:35] sc1
    v_add_u32 v16, 6144, v13
    global_load_dwordx2 v[54:55], v16, s[34:35] sc1
    v_add_u32 v16, 8192, v13
    global_load_dwordx2 v[56:57], v16, s[34:35] sc1
    v_add_u32 v16, 10240, v13
    global_load_dwordx2 v[58:59], v16, s[34:35] sc1
    v_add_u32 v16, 12288, v13
    global_load_dwordx2 v[60:61], v16, s[34:35] sc1
    v_add_u32 v16, 14336, v13
    global_load_dwordx2 v[62:63], v16, s[34:35] sc1
    s_waitcnt vmcnt(0)
    s_branch L_poll2
L_poll2_done:
    v_mov_b32 v128, 0
    v_mov_b32 v129, 0
    v_mov_b32 v130, 0
    v_mov_b32 v131, 0
    v_mov_b32 v132, 0
    v_mov_b32 v133, 0
    v_mov_b32 v134, 0
    v_mov_b32 v135, 0
    v_mov_b32 v136, 0
    v_mov_b32 v137, 0
    v_mov_b32 v138, 0
    v_mov_b32 v139, 0
    v_mov_b32 v140, 0
    v_mov_b32 v141, 0
    v_mov_b32 v142, 0
    v_mov_b32 v143, 0
    v_mov_b32 v144, 0
    v_mov_b32 v145, 0
    v_mov_b32 v146, 0
    v_mov_b32 v147, 0
    v_mov_b32 v148, 0
    v_mov_b32 v149, 0
    v_mov_b32 v150, 0
    v_mov_b32 v151, 0
    v_mov_b32 v152, 0
    v_mov_b32 v153, 0
    v_mov_b32 v154, 0
    v_mov_b32 v155, 0
    v_mov_b32 v156, 0
    v_mov_b32 v157, 0
    v_mov_b32 v158, 0
    v_mov_b32 v159, 0
    ds_read_u16_d16_hi v128, v14 offset:3584
    ds_read_u16_d16_hi v129, v14 offset:8192
    ds_read_u16_d16_hi v130, v14 offset:12800
    ds_read_u16_d16_hi v131, v14 offset:17408
    ds_read_u16_d16_hi v132, v14 offset:3072
    ds_read_u16_d16_hi v133, v14 offset:7680
    ds_read_u16_d16_hi v134, v14 offset:12288
    ds_read_u16_d16_hi v135, v14 offset:16896
    ds_read_u16_d16_hi v136, v14 offset:2560
    ds_read_u16_d16_hi v137, v14 offset:7168
    ds_read_u16_d16_hi v138, v14 offset:11776
    ds_read_u16_d16_hi v139, v14 offset:16384
    ds_read_u16_d16_hi v140, v14 offset:2048
    ds_read_u16_d16_hi v141, v14 offset:6656
    ds_read_u16_d16_hi v142, v14 offset:11264
    ds_read_u16_d16_hi v143, v14 offset:15872
    ds_read_u16_d16_hi v144, v14 offset:1536
    ds_read_u16_d16_hi v145, v14 offset:6144
    ds_read_u16_d16_hi v146, v14 offset:10752
    ds_read_u16_d16_hi v147, v14 offset:15360
    ds_read_u16_d16_hi v148, v14 offset:1024
    ds_read_u16_d16_hi v149, v14 offset:5632
    ds_read_u16_d16_hi v150, v14 offset:10240
    ds_read_u16_d16_hi v151, v14 offset:14848
    ds_read_u16_d16_hi v152, v14 offset:512
    ds_read_u16_d16_hi v153, v14 offset:5120
    ds_read_u16_d16_hi v154, v14 offset:9728
    ds_read_u16_d16_hi v155, v14 offset:14336
    ds_read_u16_d16_hi v156, v14 offset:0
    ds_read_u16_d16_hi v157, v14 offset:4608
    ds_read_u16_d16_hi v158, v14 offset:9216
    ds_read_u16_d16_hi v159, v14 offset:13824
    s_waitcnt lgkmcnt(0)
    v_mul_f32 v66, v130, v26
    v_mul_f32 v67, v131, v27
    v_sub_f32 v68, 1.0, v48
    v_mul_f32 v64, v130, v48
    v_mul_f32 v65, v131, v48
    v_cvt_pk_bf16_f32 v41, v66, v67
    v_lshlrev_b32 v66, 16, v41
    v_and_b32 v67, 0xffff0000, v41
    v_cvt_pk_bf16_f32 v42, v68, v68
    v_and_b32 v68, 0xffff0000, v42
    v_mul_f32 v74, v134, v26
    v_mul_f32 v75, v135, v27
    v_sub_f32 v76, 1.0, v50
    v_mul_f32 v72, v134, v50
    v_mul_f32 v73, v135, v50
    v_cvt_pk_bf16_f32 v41, v74, v75
    v_lshlrev_b32 v74, 16, v41
    v_and_b32 v75, 0xffff0000, v41
    v_cvt_pk_bf16_f32 v42, v76, v76
    v_and_b32 v76, 0xffff0000, v42
    s_mov_b32 s28, 0
    v_add_u32 v18, 0, v15
L_ypoll0:
    ds_read_b32 v17, v9 offset:0
    ds_read_b32 v30, v12 offset:2048
    ds_read_b32 v31, v12 offset:3072
    ds_read_b32 v28, v12 offset:0
    ds_read_b32 v29, v12 offset:1024
    s_add_u32 s28, s28, 1
    s_waitcnt lgkmcnt(4)
    v_cmp_ne_u32 vcc, 1, v17
    s_cmp_gt_u32 s28, 0x400000
    s_cbranch_scc1 L_ygo0
    s_cbranch_vccz L_ygo0
    s_waitcnt lgkmcnt(0)
    s_sleep 1
    s_branch L_ypoll0
L_ygo0:
    s_waitcnt lgkmcnt(2)
    v_cvt_pk_bf16_f32 v41, v30, v31
    v_lshlrev_b32 v30, 16, v41
    v_and_b32 v31, 0xffff0000, v41
    v_add_f32 v30, v30, v66
    v_add_f32 v31, v31, v67
    v_cvt_pk_bf16_f32 v41, v30, v31
    v_lshlrev_b32 v30, 16, v41
    v_and_b32 v31, 0xffff0000, v41
    v_mul_f32 v30, v30, v68
    v_mul_f32 v31, v31, v68
    s_waitcnt lgkmcnt(0)
    v_fmac_f32 v28, v128, v24
    v_fmac_f32 v29, v129, v25
    v_cvt_pk_bf16_f32 v41, v30, v31
    v_lshlrev_b32 v30, 16, v41
    v_and_b32 v31, 0xffff0000, v41
    v_fmac_f32 v30, v28, v64
    v_fmac_f32 v31, v29, v65
    v_cvt_pk_bf16_f32 v19, v30, v31
    global_store_dword v18, v19, s[36:37]
    v_mul_f32 v82, v138, v26
    v_mul_f32 v83, v139, v27
    v_sub_f32 v84, 1.0, v52
    v_mul_f32 v80, v138, v52
    v_mul_f32 v81, v139, v52
    v_cvt_pk_bf16_f32 v41, v82, v83
    v_lshlrev_b32 v82, 16, v41
    v_and_b32 v83, 0xffff0000, v41
    v_cvt_pk_bf16_f32 v42, v84, v84
    v_and_b32 v84, 0xffff0000, v42
    s_mov_b32 s28, 0
    v_add_u32 v18, 262144, v15
L_ypoll1:
    ds_read_b32 v17, v9 offset:1024
    ds_read_b32 v30, v12 offset:6144
    ds_read_b32 v31, v12 offset:7168
    ds_read_b32 v28, v12 offset:4096
    ds_read_b32 v29, v12 offset:5120
    s_add_u32 s28, s28, 1
    s_waitcnt lgkmcnt(4)
    v_cmp_ne_u32 vcc, 1, v17
    s_cmp_gt_u32 s28, 0x400000
    s_cbranch_scc1 L_ygo1
    s_cbranch_vccz L_ygo1
    s_waitcnt lgkmcnt(0)
    s_sleep 1
    s_branch L_ypoll1
L_ygo1:
    s_waitcnt lgkmcnt(2)
    v_cvt_pk_bf16_f32 v41, v30, v31
    v_lshlrev_b32 v30, 16, v41
    v_and_b32 v31, 0xffff0000, v41
    v_add_f32 v30, v30, v74
    v_add_f32 v31, v31, v75
    v_cvt_pk_bf16_f32 v41, v30, v31
    v_lshlrev_b32 v30, 16, v41
    v_and_b32 v31, 0xffff0000, v41
    v_mul_f32 v30, v30, v76
    v_mul_f32 v31, v31, v76
    s_waitcnt lgkmcnt(0)
    v_fmac_f32 v28, v132, v24
    v_fmac_f32 v29, v133, v25
    v_cvt_pk_bf16_f32 v41, v30, v31
    v_lshlrev_b32 v30, 16, v41
    v_and_b32 v31, 0xffff0000, v41
    v_fmac_f32 v30, v28, v72
    v_fmac_f32 v31, v29, v73
    v_cvt_pk_bf16_f32 v19, v30, v31
    global_store_dword v18, v19, s[36:37]
    v_mul_f32 v90, v142, v26
    v_mul_f32 v91, v143, v27
    v_sub_f32 v92, 1.0, v54
    v_mul_f32 v88, v142, v54
    v_mul_f32 v89, v143, v54
    v_cvt_pk_bf16_f32 v41, v90, v91
    v_lshlrev_b32 v90, 16, v41
    v_and_b32 v91, 0xffff0000, v41
    v_cvt_pk_bf16_f32 v42, v92, v92
    v_and_b32 v92, 0xffff0000, v42
    s_mov_b32 s28, 0
    v_add_u32 v18, 524288, v15
L_ypoll2:
    ds_read_b32 v17, v9 offset:2048
    ds_read_b32 v30, v12 offset:10240
    ds_read_b32 v31, v12 offset:11264
    ds_read_b32 v28, v12 offset:8192
    ds_read_b32 v29, v12 offset:9216
    s_add_u32 s28, s28, 1
    s_waitcnt lgkmcnt(4)
    v_cmp_ne_u32 vcc, 1, v17
    s_cmp_gt_u32 s28, 0x400000
    s_cbranch_scc1 L_ygo2
    s_cbranch_vccz L_ygo2
    s_waitcnt lgkmcnt(0)
    s_sleep 1
    s_branch L_ypoll2
L_ygo2:
    s_waitcnt lgkmcnt(2)
    v_cvt_pk_bf16_f32 v41, v30, v31
    v_lshlrev_b32 v30, 16, v41
    v_and_b32 v31, 0xffff0000, v41
    v_add_f32 v30, v30, v82
    v_add_f32 v31, v31, v83
    v_cvt_pk_bf16_f32 v41, v30, v31
    v_lshlrev_b32 v30, 16, v41
    v_and_b32 v31, 0xffff0000, v41
    v_mul_f32 v30, v30, v84
    v_mul_f32 v31, v31, v84
    s_waitcnt lgkmcnt(0)
    v_fmac_f32 v28, v136, v24
    v_fmac_f32 v29, v137, v25
    v_cvt_pk_bf16_f32 v41, v30, v31
    v_lshlrev_b32 v30, 16, v41
    v_and_b32 v31, 0xffff0000, v41
    v_fmac_f32 v30, v28, v80
    v_fmac_f32 v31, v29, v81
    v_cvt_pk_bf16_f32 v19, v30, v31
    global_store_dword v18, v19, s[36:37]
    v_mul_f32 v98, v146, v26
    v_mul_f32 v99, v147, v27
    v_sub_f32 v100, 1.0, v56
    v_mul_f32 v96, v146, v56
    v_mul_f32 v97, v147, v56
    v_cvt_pk_bf16_f32 v41, v98, v99
    v_lshlrev_b32 v98, 16, v41
    v_and_b32 v99, 0xffff0000, v41
    v_cvt_pk_bf16_f32 v42, v100, v100
    v_and_b32 v100, 0xffff0000, v42
    s_mov_b32 s28, 0
    v_add_u32 v18, 786432, v15
L_ypoll3:
    ds_read_b32 v17, v9 offset:3072
    ds_read_b32 v30, v12 offset:14336
    ds_read_b32 v31, v12 offset:15360
    ds_read_b32 v28, v12 offset:12288
    ds_read_b32 v29, v12 offset:13312
    s_add_u32 s28, s28, 1
    s_waitcnt lgkmcnt(4)
    v_cmp_ne_u32 vcc, 1, v17
    s_cmp_gt_u32 s28, 0x400000
    s_cbranch_scc1 L_ygo3
    s_cbranch_vccz L_ygo3
    s_waitcnt lgkmcnt(0)
    s_sleep 1
    s_branch L_ypoll3
L_ygo3:
    s_waitcnt lgkmcnt(2)
    v_cvt_pk_bf16_f32 v41, v30, v31
    v_lshlrev_b32 v30, 16, v41
    v_and_b32 v31, 0xffff0000, v41
    v_add_f32 v30, v30, v90
    v_add_f32 v31, v31, v91
    v_cvt_pk_bf16_f32 v41, v30, v31
    v_lshlrev_b32 v30, 16, v41
    v_and_b32 v31, 0xffff0000, v41
    v_mul_f32 v30, v30, v92
    v_mul_f32 v31, v31, v92
    s_waitcnt lgkmcnt(0)
    v_fmac_f32 v28, v140, v24
    v_fmac_f32 v29, v141, v25
    v_cvt_pk_bf16_f32 v41, v30, v31
    v_lshlrev_b32 v30, 16, v41
    v_and_b32 v31, 0xffff0000, v41
    v_fmac_f32 v30, v28, v88
    v_fmac_f32 v31, v29, v89
    v_cvt_pk_bf16_f32 v19, v30, v31
    global_store_dword v18, v19, s[36:37]
    v_mul_f32 v106, v150, v26
    v_mul_f32 v107, v151, v27
    v_sub_f32 v108, 1.0, v58
    v_mul_f32 v104, v150, v58
    v_mul_f32 v105, v151, v58
    v_cvt_pk_bf16_f32 v41, v106, v107
    v_lshlrev_b32 v106, 16, v41
    v_and_b32 v107, 0xffff0000, v41
    v_cvt_pk_bf16_f32 v42, v108, v108
    v_and_b32 v108, 0xffff0000, v42
    s_mov_b32 s28, 0
    v_add_u32 v18, 1048576, v15
L_ypoll4:
    ds_read_b32 v17, v9 offset:4096
    ds_read_b32 v30, v12 offset:18432
    ds_read_b32 v31, v12 offset:19456
    ds_read_b32 v28, v12 offset:16384
    ds_read_b32 v29, v12 offset:17408
    s_add_u32 s28, s28, 1
    s_waitcnt lgkmcnt(4)
    v_cmp_ne_u32 vcc, 1, v17
    s_cmp_gt_u32 s28, 0x400000
    s_cbranch_scc1 L_ygo4
    s_cbranch_vccz L_ygo4
    s_waitcnt lgkmcnt(0)
    s_sleep 1
    s_branch L_ypoll4
L_ygo4:
    s_waitcnt lgkmcnt(2)
    v_cvt_pk_bf16_f32 v41, v30, v31
    v_lshlrev_b32 v30, 16, v41
    v_and_b32 v31, 0xffff0000, v41
    v_add_f32 v30, v30, v98
    v_add_f32 v31, v31, v99
    v_cvt_pk_bf16_f32 v41, v30, v31
    v_lshlrev_b32 v30, 16, v41
    v_and_b32 v31, 0xffff0000, v41
    v_mul_f32 v30, v30, v100
    v_mul_f32 v31, v31, v100
    s_waitcnt lgkmcnt(0)
    v_fmac_f32 v28, v144, v24
    v_fmac_f32 v29, v145, v25
    v_cvt_pk_bf16_f32 v41, v30, v31
    v_lshlrev_b32 v30, 16, v41
    v_and_b32 v31, 0xffff0000, v41
    v_fmac_f32 v30, v28, v96
    v_fmac_f32 v31, v29, v97
    v_cvt_pk_bf16_f32 v19, v30, v31
    global_store_dword v18, v19, s[36:37]
    v_mul_f32 v114, v154, v26
    v_mul_f32 v115, v155, v27
    v_sub_f32 v116, 1.0, v60
    v_mul_f32 v112, v154, v60
    v_mul_f32 v113, v155, v60
    v_cvt_pk_bf16_f32 v41, v114, v115
    v_lshlrev_b32 v114, 16, v41
    v_and_b32 v115, 0xffff0000, v41
    v_cvt_pk_bf16_f32 v42, v116, v116
    v_and_b32 v116, 0xffff0000, v42
    s_mov_b32 s28, 0
    v_add_u32 v18, 1310720, v15
L_ypoll5:
    ds_read_b32 v17, v9 offset:5120
    ds_read_b32 v30, v12 offset:22528
    ds_read_b32 v31, v12 offset:23552
    ds_read_b32 v28, v12 offset:20480
    ds_read_b32 v29, v12 offset:21504
    s_add_u32 s28, s28, 1
    s_waitcnt lgkmcnt(4)
    v_cmp_ne_u32 vcc, 1, v17
    s_cmp_gt_u32 s28, 0x400000
    s_cbranch_scc1 L_ygo5
    s_cbranch_vccz L_ygo5
    s_waitcnt lgkmcnt(0)
    s_sleep 1
    s_branch L_ypoll5
L_ygo5:
    s_waitcnt lgkmcnt(2)
    v_cvt_pk_bf16_f32 v41, v30, v31
    v_lshlrev_b32 v30, 16, v41
    v_and_b32 v31, 0xffff0000, v41
    v_add_f32 v30, v30, v106
    v_add_f32 v31, v31, v107
    v_cvt_pk_bf16_f32 v41, v30, v31
    v_lshlrev_b32 v30, 16, v41
    v_and_b32 v31, 0xffff0000, v41
    v_mul_f32 v30, v30, v108
    v_mul_f32 v31, v31, v108
    s_waitcnt lgkmcnt(0)
    v_fmac_f32 v28, v148, v24
    v_fmac_f32 v29, v149, v25
    v_cvt_pk_bf16_f32 v41, v30, v31
    v_lshlrev_b32 v30, 16, v41
    v_and_b32 v31, 0xffff0000, v41
    v_fmac_f32 v30, v28, v104
    v_fmac_f32 v31, v29, v105
    v_cvt_pk_bf16_f32 v19, v30, v31
    global_store_dword v18, v19, s[36:37]
    v_mul_f32 v122, v158, v26
    v_mul_f32 v123, v159, v27
    v_sub_f32 v124, 1.0, v62
    v_mul_f32 v120, v158, v62
    v_mul_f32 v121, v159, v62
    v_cvt_pk_bf16_f32 v41, v122, v123
    v_lshlrev_b32 v122, 16, v41
    v_and_b32 v123, 0xffff0000, v41
    v_cvt_pk_bf16_f32 v42, v124, v124
    v_and_b32 v124, 0xffff0000, v42
    s_mov_b32 s28, 0
    v_add_u32 v18, 1572864, v15
L_ypoll6:
    ds_read_b32 v17, v9 offset:6144
    ds_read_b32 v30, v12 offset:26624
    ds_read_b32 v31, v12 offset:27648
    ds_read_b32 v28, v12 offset:24576
    ds_read_b32 v29, v12 offset:25600
    s_add_u32 s28, s28, 1
    s_waitcnt lgkmcnt(4)
    v_cmp_ne_u32 vcc, 1, v17
    s_cmp_gt_u32 s28, 0x400000
    s_cbranch_scc1 L_ygo6
    s_cbranch_vccz L_ygo6
    s_waitcnt lgkmcnt(0)
    s_sleep 1
    s_branch L_ypoll6
L_ygo6:
    s_waitcnt lgkmcnt(2)
    v_cvt_pk_bf16_f32 v41, v30, v31
    v_lshlrev_b32 v30, 16, v41
    v_and_b32 v31, 0xffff0000, v41
    v_add_f32 v30, v30, v114
    v_add_f32 v31, v31, v115
    v_cvt_pk_bf16_f32 v41, v30, v31
    v_lshlrev_b32 v30, 16, v41
    v_and_b32 v31, 0xffff0000, v41
    v_mul_f32 v30, v30, v116
    v_mul_f32 v31, v31, v116
    s_waitcnt lgkmcnt(0)
    v_fmac_f32 v28, v152, v24
    v_fmac_f32 v29, v153, v25
    v_cvt_pk_bf16_f32 v41, v30, v31
    v_lshlrev_b32 v30, 16, v41
    v_and_b32 v31, 0xffff0000, v41
    v_fmac_f32 v30, v28, v112
    v_fmac_f32 v31, v29, v113
    v_cvt_pk_bf16_f32 v19, v30, v31
    global_store_dword v18, v19, s[36:37]
    s_mov_b32 s28, 0
    v_add_u32 v18, 1835008, v15
L_ypoll7:
    ds_read_b32 v17, v9 offset:7168
    ds_read_b32 v30, v12 offset:30720
    ds_read_b32 v31, v12 offset:31744
    ds_read_b32 v28, v12 offset:28672
    ds_read_b32 v29, v12 offset:29696
    s_add_u32 s28, s28, 1
    s_waitcnt lgkmcnt(4)
    v_cmp_ne_u32 vcc, 1, v17
    s_cmp_gt_u32 s28, 0x400000
    s_cbranch_scc1 L_ygo7
    s_cbranch_vccz L_ygo7
    s_waitcnt lgkmcnt(0)
    s_sleep 1
    s_branch L_ypoll7
L_ygo7:
    s_waitcnt lgkmcnt(2)
    v_cvt_pk_bf16_f32 v41, v30, v31
    v_lshlrev_b32 v30, 16, v41
    v_and_b32 v31, 0xffff0000, v41
    v_add_f32 v30, v30, v122
    v_add_f32 v31, v31, v123
    v_cvt_pk_bf16_f32 v41, v30, v31
    v_lshlrev_b32 v30, 16, v41
    v_and_b32 v31, 0xffff0000, v41
    v_mul_f32 v30, v30, v124
    v_mul_f32 v31, v31, v124
    s_waitcnt lgkmcnt(0)
    v_fmac_f32 v28, v156, v24
    v_fmac_f32 v29, v157, v25
    v_cvt_pk_bf16_f32 v41, v30, v31
    v_lshlrev_b32 v30, 16, v41
    v_and_b32 v31, 0xffff0000, v41
    v_fmac_f32 v30, v28, v120
    v_fmac_f32 v31, v29, v121
    v_cvt_pk_bf16_f32 v19, v30, v31
    global_store_dword v18, v19, s[36:37]
L_fin:
L_end:
    s_endpgm

.section .rodata,"a"
.p2align 6
.amdhsa_kernel gated_mix__ssm_conv_h3__ssm_conv_s4__prompt_kernel
  .amdhsa_next_free_vgpr 256
  .amdhsa_next_free_sgpr 102
  .amdhsa_accum_offset 256
  .amdhsa_group_segment_fixed_size 0
  .amdhsa_kernarg_size 152
  .amdhsa_user_sgpr_count 2
  .amdhsa_user_sgpr_kernarg_segment_ptr 1
  .amdhsa_system_sgpr_workgroup_id_x 1
.end_amdhsa_kernel
```
